```python
import torch

def _softmax(x, axis=-1):
    return torch.softmax(x, dim=axis)
def _gelu(x):
    return torch.nn.functional.gelu(x, approximate="tanh")
def _silu(x):
    return torch.nn.functional.silu(x)
def _sigmoid(x):
    return torch.sigmoid(x)
def _layernorm(x, axis=-1, eps=1e-5):
    m = x.mean(dim=axis, keepdim=True)
    v = x.var(dim=axis, keepdim=True, unbiased=False)
    return (x - m) / torch.sqrt(v + eps)
def _scatter_add(tgt, idx, src, axis=0):
    return tgt.clone().index_add_(axis, idx, src)
def _segment_sum(src, seg, n):
    out = torch.zeros((n,) + src.shape[1:], dtype=src.dtype)
    return out.index_add_(0, seg, src)
def _pad(x, pw):
    flat = tuple(v for pair in reversed(pw) for v in pair)
    return torch.nn.functional.pad(x, flat)

kernel_name = 'parallel_sum__linear_attn_block__dense_activation_squared_relu__prompt'

def setup_inputs():

    _w = (lambda a: (lambda t: t.to(torch.bfloat16) if t.is_floating_point() else t)(torch.as_tensor(a)))
    def _A_setup():
        B, S, D = 1, 2048, 512
        return {
            "x": _w((lambda *s: torch.randn(*s, dtype=torch.bfloat16) * 0.05)(B, S, D)),
            "wqkv": _w((lambda *s: torch.randn(*s, dtype=torch.bfloat16) * 0.4)(D, 3 * D)),
            "wo": _w((lambda *s: torch.randn(*s, dtype=torch.bfloat16) * 0.2)(D, D)),
        }
    _A_in = _A_setup()

    def _B_setup():
        B, S, D, F = 1, 2048, 512, 1376
        return {
            "x": _w((lambda *s: torch.randn(*s, dtype=torch.bfloat16) * 0.05)(B, S, D)),
            "w1": _w((lambda *s: torch.randn(*s, dtype=torch.bfloat16) * 0.05)(D, F)),
            "b1": _w((lambda *s: torch.randn(*s, dtype=torch.bfloat16) * 0.2)(F)),
            "w2": _w((lambda *s: torch.randn(*s, dtype=torch.bfloat16) * 0.05)(F, D)),
            "b2": _w((lambda *s: torch.randn(*s, dtype=torch.bfloat16) * 0.8)(D)),
        }
    _B_in = _B_setup()

    return {
        "A_x": _A_in["x"],
        "A_wqkv": _A_in["wqkv"],
        "A_wo": _A_in["wo"],
        "B_x": _B_in["x"],
        "B_w1": _B_in["w1"],
        "B_b1": _B_in["b1"],
        "B_w2": _B_in["w2"],
        "B_b2": _B_in["b2"],
    }

def reference(A_x, A_wqkv, A_wo, B_x, B_w1, B_b1, B_w2, B_b2):
    def _A_ref(x, wqkv, wo):
        B, S, D = x.shape
        H = 32; Dh = D // H
        qkv = (lambda x, *d: x.permute(*d))((x @ wqkv).reshape(B, S, 3, H, Dh), 2, 0, 3, 1, 4)
        q, k, v = qkv[0], qkv[1], qkv[2]
        phi = lambda t: torch.where(t > 0, t + 1, torch.exp(t)) + 1e-6
        pq, pk = phi(q), phi(k)
        kv = torch.einsum("bhsd,bhse->bhde", pk, v)
        z = torch.einsum("bhsd->bhd", pk)
        num = torch.einsum("bhqd,bhde->bhqe", pq, kv)
        den = torch.einsum("bhqd,bhd->bhq", pq, z)[..., None] + 1e-6
        o = num / den
        return (lambda x, *d: x.permute(*d))(o, 0, 2, 1, 3).reshape(B, S, D) @ wo

    def _B_ref(x, w1, b1, w2, b2):
        h = torch.einsum("bsd,df->bsf", x, w1) + b1
        zero = torch.zeros_like(h)
        r = torch.where(h > zero, h, zero)
        h = r * r
        out = torch.einsum("bsf,fd->bsd", h, w2) + b2
        return out

    x = A_x
    xn = _layernorm(x, axis=-1)
    return x + _A_ref(xn, A_wqkv, A_wo) + _B_ref(xn, B_w1, B_b1, B_w2, B_b2)
```

```asm
; @launch grid=(256,1,1) block=(512,1,1) lds=163840
.amdgcn_target "amdgcn-amd-amdhsa--gfx950"
.text
.globl parallel_sum__linear_attn_block__dense_activation_squared_relu__prompt_kernel
.p2align 12
.p2align 8
.type parallel_sum__linear_attn_block__dense_activation_squared_relu__prompt_kernel,@function
parallel_sum__linear_attn_block__dense_activation_squared_relu__prompt_kernel:
    s_cmp_ge_u32 s2, 0x100
    s_cbranch_scc1 L_end
    s_load_dwordx16 s[4:19], s[0:1], 0
    s_load_dwordx2 s[20:21], s[0:1], 64
    s_load_dwordx2 s[24:25], s[0:1], 80
    s_lshr_b32 s46, s2, 3
    s_getpc_b64 s[22:23]
L_pc:
    s_lshl_b32 s54, s46, 10
    v_and_b32 v3, 0x1c0, v0
    v_lshl_add_u32 v3, v3, 1, s54
    v_min_u32 v3, L_end-L_pc, v3
    global_load_dword v255, v3, s[22:23]
    v_lshrrev_b32 v2, 6, v0
    v_and_b32 v1, 63, v0
    v_readfirstlane_b32 s44, v2
    s_lshl_b32 s47, s2, 2
    s_lshr_b32 s47, 1884566038, s47
    s_and_b32 s47, s47, 7
    s_and_b32 s54, s47, 1
    s_and_b32 s55, s46, 7
    s_lshl3_add_u32 s48, s54, s55
    s_lshr_b32 s56, s46, 3
    s_lshr_b32 s50, s56, 1
    s_and_b32 s57, s56, 1
    s_and_b32 s49, s47, 6
    s_add_u32 s49, s49, s57
    s_lshl3_add_u32 s53, s50, s49
    s_lshr_b32 s58, s47, 1
    s_mul_i32 s51, s58, 22
    s_cmp_lt_u32 s49, 6
    s_cselect_b32 s59, 12, 10
    s_cmp_eq_u32 s57, 0
    s_cselect_b32 s52, s59, 10
    s_cselect_b32 s59, 0, s59
    s_add_u32 s51, s51, s59
    s_and_b32 s45, s44, 3
    s_cmp_lt_u32 s44, 4
    s_cbranch_scc1 L_A
    s_setprio 1
    v_lshrrev_b32 v230, 3, v1
    v_and_b32 v231, 7, v1
    v_lshrrev_b32 v232, 4, v1
    v_xor_b32 v232, v232, v231
    v_lshlrev_b32 v232, 4, v232
    v_lshl_add_u32 v208, v230, 10, v232
    v_xor_b32 v209, 0x2040, v208
    s_add_u32 s59, s55, s56
    s_bfe_u32 s66, s59, 65537
    s_and_b32 s59, s59, 1
    s_lshl_b32 s67, s58, 2
    s_lshr_b32 s67, 0x6240, s67
    s_lshl2_add_u32 s67, s54, s67
    s_lshl1_add_u32 s54, s45, s59
    s_xor_b32 s55, s54, 1
    s_lshl_b32 s59, s59, 2
    s_lshl_b32 s56, s49, 7
    s_lshl_b32 s57, s51, 5
    s_movk_i32 s64, 2752
    s_movk_i32 s65, 128
    s_cmp_eq_u32 s50, 0
    s_cselect_b32 s64, 3072, s64
    s_cselect_b32 s65, 1024, s65
    s_cselect_b32 s52, 12, s52
    s_cselect_b32 s56, s56, s57
    v_bitop3_b32 v232, v230, 2, v231 bitop3:0x6a
    v_xor_b32 v232, s59, v232
    v_mul_u32_u24 v233, s64, v230
    s_lshl1_add_u32 s57, s52, -16
    v_xor_b32 v234, 4, v232
    v_cmp_gt_u32 vcc, s57, v232
    v_mov_b32 v235, 1073741824
    v_lshl_add_u32 v210, v232, 4, v233
    v_cndmask_b32 v211, v235, v210, vcc
    v_cmp_gt_u32 vcc, s57, v234
    v_lshl_add_u32 v212, v234, 4, v233
    s_lshl_b32 s76, s54, 10
    s_lshl_b32 s74, s54, 11
    s_mul_i32 s80, s54, s64
    s_lshl3_add_u32 s80, s80, s56
    s_lshl3_add_u32 s78, s48, s54
    s_lshl_b32 s78, s78, 14
    s_lshl_b32 s77, s55, 10
    s_lshl_b32 s75, s55, 11
    s_mul_i32 s81, s55, s64
    s_lshl3_add_u32 s81, s81, s56
    s_lshl3_add_u32 s79, s48, s55
    s_lshl_b32 s79, s79, 14
    v_cndmask_b32 v213, v235, v212, vcc
    s_lshl_b32 s64, s64, 6
    s_mov_b32 s30, 2097152
    s_mov_b32 s31, 0x20000
    s_lshl_b32 s34, s64, 3
    s_mov_b32 s35, 0x20000
    s_xor_b32 s61, s66, 0
    s_add_u32 s61, s61, s67
    s_and_b32 s61, s61, 7
    s_lshl_b32 s70, s61, 7
    s_mul_i32 s61, s61, s64
    s_cmp_eq_u32 s50, 0
    s_waitcnt lgkmcnt(0)
    s_mov_b64 s[28:29], s[4:5]
    s_cselect_b64 s[32:33], s[6:7], s[12:13]
    s_add_u32 m0, s76, 16384
    s_add_u32 s69, s61, s80
    buffer_load_dwordx4 v210, s[32:35], s69 offen  lds
    s_addk_i32 m0, 8192
    s_add_u32 s69, s69, s65
    buffer_load_dwordx4 v210, s[32:35], s69 offen  lds
    s_addk_i32 m0, 8192
    s_add_u32 s69, s69, s65
    buffer_load_dwordx4 v211, s[32:35], s69 offen  lds
    s_add_u32 m0, s74, 0
    s_add_u32 s68, s70, s78
    buffer_load_dwordx4 v208, s[28:31], s68 offen  lds
    s_addk_i32 m0, 1024
    s_nop 0
    buffer_load_dwordx4 v209, s[28:31], s68 offen  lds
    s_add_u32 m0, s75, 0
    s_add_u32 s68, s70, s79
    buffer_load_dwordx4 v208, s[28:31], s68 offen  lds
    s_add_u32 s62, s24, 15368192
    s_addc_u32 s63, s25, 0
    s_load_dwordx2 s[26:27], s[62:63], 0
    v_lshrrev_b32 v232, 4, v1
    v_bfe_u32 v233, v1, 2, 2
    v_lshl_add_u32 v234, v232, 3, v233
    v_lshlrev_b32 v234, 7, v234
    v_bfe_u32 v233, v1, 3, 2
    v_xor_b32 v233, s45, v233
    v_lshl_add_u32 v234, v233, 5, v234
    v_and_b32 v233, 3, v1
    v_lshl_add_u32 v219, v233, 3, v234
    v_add_u32 v220, 40960, v219
    v_add_u32 v221, 81920, v219
    v_mov_b32 v56, 0x3f803f80
    v_mov_b32 v57, 0x3f803f80
    v_mov_b32 v58, 0x3f803f80
    v_mov_b32 v59, 0x3f803f80
    v_mov_b64 v[206:207], 0
    s_mov_b32 s40, s24
    s_mov_b32 s41, s25
    s_mov_b32 s42, 15368320
    s_mov_b32 s43, 0x20000
    s_mov_b32 s36, s16
    s_mov_b32 s37, s17
    s_mov_b32 s38, 1409024
    s_mov_b32 s39, 0x20000
    v_lshlrev_b32 v2, 4, v1
    v_lshrrev_b32 v233, 5, v1
    v_and_b32 v217, 0x1f0, v2
    v_lshl_add_u32 v214, v233, 10, v217
    v_cmp_eq_u32 vcc, 0, v217
    v_lshlrev_b32 v233, 4, v233
    s_lshl4_add_u32 s54, s48, s53
    s_lshl2_add_u32 s54, s54, s45
    v_cndmask_b32 v215, v235, v233, vcc
    s_lshl_b32 s55, s54, 11
    s_lshl_b32 s54, s54, 5
    s_add_u32 s54, s54, 12189696
    v_cmp_gt_u32 vcc, 16, v1
    s_nop 1
    v_cndmask_b32 v216, v235, v2, vcc
    v_and_b32 v233, 2, v230
    v_and_b32 v218, 0xf0, v2
    s_lshl_b32 s56, s45, 6
    v_lshrrev_b32 v228, 2, v218
    v_lshrrev_b32 v227, 2, v217
    v_add_u32 v228, s56, v228
    v_lshl_add_u32 v227, s56, 1, v227
    v_add_u32 v228, 141312, v228
    v_lshlrev_b32 v226, 1, v227
    v_add_u32 v227, 132096, v227
    v_add_u32 v226, 131072, v226
    s_lshl2_add_u32 s56, s45, 142336
    v_mov_b32 v229, s56
    ds_write_b32 v229, v206
    v_lshlrev_b32 v233, 1, v233
    v_xor_b32 v233, v233, v231
    v_lshlrev_b32 v233, 4, v233
    v_lshl_add_u32 v3, v230, 10, v233
    s_mul_i32 s71, s45, 10240
    v_bfe_u32 v234, v1, 2, 2
    v_lshrrev_b32 v233, 5, v1
    v_lshl_add_u32 v234, v233, 3, v234
    v_lshlrev_b32 v234, 7, v234
    v_bfe_u32 v233, v1, 4, 1
    v_lshl_add_u32 v234, v233, 5, v234
    v_bfe_u32 v233, v1, 3, 1
    v_lshl_add_u32 v234, v233, 6, v234
    v_and_b32 v233, 3, v1
    v_lshl_add_u32 v234, v233, 3, v234
    v_add_u32 v6, s71, v234
    v_xor_b32 v7, 64, v6
    v_add_u32 v8, 81920, v6
    v_add_u32 v9, 81920, v7
    s_mul_i32 s58, s45, 1280
    v_bfe_u32 v232, v1, 2, 1
    v_mul_u32_u24 v232, 5120, v232
    v_bfe_u32 v233, v1, 3, 1
    v_mul_u32_u24 v233, 272, v233
    v_bfe_u32 v234, v1, 4, 1
    v_mul_u32_u24 v234, 640, v234
    v_add3_u32 v232, v232, v233, v234
    v_lshrrev_b32 v233, 5, v1
    v_lshl_add_u32 v232, v233, 7, v232
    v_and_b32 v233, 3, v1
    v_lshl_add_u32 v232, v233, 5, v232
    v_add_u32 v180, s58, v232
    v_add_u32 v181, 16, v180
    v_lshlrev_b32 v236, 4, v231
    v_lshl_add_u32 v4, v230, 10, v236
    v_lshlrev_b32 v5, 8, v231
    v_mul_u32_u24 v234, 43, v1
    v_lshrrev_b32 v234, 10, v234
    v_lshl_add_u32 v234, v234, 3, v1
    v_lshlrev_b32 v2, 4, v234
    v_lshlrev_b32 v234, 10, v1
    v_cmp_gt_u32 vcc, 4, v1
    v_add_u32 v234, 384, v234
    s_lshr_b32 s15, s46, 3
    v_lshlrev_b32 v233, 7, v1
    v_cndmask_b32 v225, v235, v234, vcc
    v_cndmask_b32 v223, v235, v233, vcc
    v_cmp_gt_u32 vcc, 11, v1
    s_and_b32 s4, s47, 1
    s_lshr_b32 s58, s47, 1
    s_lshl2_add_u32 s4, s4, s58
    s_lshl2_add_u32 s4, s4, s15
    v_cndmask_b32 v224, v235, v234, vcc
    v_cndmask_b32 v222, v235, v233, vcc
    s_and_b32 s15, s15, 1
    s_and_b32 s72, s46, 7
    s_lshl_b32 s72, s72, 7
    s_lshl1_add_u32 s56, s45, s15
    s_xor_b32 s57, s56, 1
    s_mul_i32 s5, s56, 180224
    s_mul_i32 s6, s57, 180224
    s_add_u32 s5, s5, s72
    s_add_u32 s6, s6, s72
    s_mul_i32 s11, s4, 362496
    s_mul_i32 s7, s56, 33792
    s_mul_i32 s10, s57, 33792
    s_add_u32 s7, s7, s11
    s_add_u32 s10, s10, s11
    s_add_u32 s11, s11, 264192
    s_lshl3_add_u32 s13, s4, s45
    s_lshl_b32 s13, s13, 13
    s_add_u32 s13, s13, s72
    s_add_u32 s59, s13, 32768
    s_lshr_b32 s14, s4, 1
    s_lshl3_add_u32 s14, s14, s45
    s_lshl_b32 s14, s14, 11
    s_add_u32 s14, s14, 12222464
    s_add_u32 s60, s14, 8192
    s_lshl4_add_u32 s56, s53, s48
    s_lshl2_add_u32 s56, s56, s45
    s_lshl_b32 s56, s56, 8
    s_add_u32 s56, s56, 11927552
    s_lshl2_add_u32 s57, s48, s45
    s_lshl_b32 s57, s57, 9
    s_add_u32 s57, s57, 12189696
    s_addk_i32 m0, 1024
    s_nop 0
    buffer_load_dwordx4 v209, s[28:31], s68 offen  lds
    s_add_u32 m0, s77, 16384
    s_add_u32 s69, s61, s81
    buffer_load_dwordx4 v212, s[32:35], s69 offen  lds
    s_addk_i32 m0, 8192
    s_add_u32 s69, s69, s65
    buffer_load_dwordx4 v212, s[32:35], s69 offen  lds
    s_addk_i32 m0, 8192
    s_add_u32 s69, s69, s65
    buffer_load_dwordx4 v213, s[32:35], s69 offen  lds
    s_barrier
    s_add_u32 m0, s74, 40960
    s_xor_b32 s61, s66, 1
    s_add_u32 s61, s61, s67
    s_and_b32 s61, s61, 7
    s_lshl_b32 s70, s61, 7
    s_mul_i32 s61, s61, s64
    s_add_u32 s68, s70, s78
    buffer_load_dwordx4 v208, s[28:31], s68 offen  lds
    s_addk_i32 m0, 1024
    s_nop 0
    buffer_load_dwordx4 v209, s[28:31], s68 offen  lds
    s_add_u32 m0, s76, 57344
    s_add_u32 s69, s61, s80
    buffer_load_dwordx4 v210, s[32:35], s69 offen  lds
    s_addk_i32 m0, 8192
    s_add_u32 s69, s69, s65
    buffer_load_dwordx4 v210, s[32:35], s69 offen  lds
    s_addk_i32 m0, 8192
    s_add_u32 s69, s69, s65
    buffer_load_dwordx4 v211, s[32:35], s69 offen  lds
    s_add_u32 m0, s75, 40960
    s_add_u32 s68, s70, s79
    buffer_load_dwordx4 v208, s[28:31], s68 offen  lds
    s_addk_i32 m0, 1024
    s_nop 0
    buffer_load_dwordx4 v209, s[28:31], s68 offen  lds
    s_add_u32 m0, s77, 57344
    s_add_u32 s69, s61, s81
    buffer_load_dwordx4 v212, s[32:35], s69 offen  lds
    s_waitcnt lgkmcnt(0)
    s_add_u32 s26, s26, 0x7f4a7c15
    s_add_u32 s27, s27, 0x9e3779b9
    v_mov_b32 v74, s26
    v_mov_b32 v75, s27
    v_mov_b32 v71, s26
    s_waitcnt vmcnt(8)
    s_barrier
    s_addk_i32 m0, 8192
    s_add_u32 s69, s69, s65
    buffer_load_dwordx4 v212, s[32:35], s69 offen  lds
    s_addk_i32 m0, 8192
    s_add_u32 s69, s69, s65
    buffer_load_dwordx4 v213, s[32:35], s69 offen  lds
    s_bitcmp1_b32 s48, 2
    s_cbranch_scc1 L_cs_1
    ds_read_b64_tr_b16 v[12:13], v219 offset:16384
    ds_read_b64_tr_b16 v[14:15], v219 offset:16896
    ds_read_b64_tr_b16 v[16:17], v219 offset:24576
    ds_read_b64_tr_b16 v[18:19], v219 offset:25088
    ds_read_b64_tr_b16 v[20:21], v219 offset:32768
    ds_read_b64_tr_b16 v[22:23], v219 offset:33280
    ds_read_b64_tr_b16 v[28:29], v219 offset:20480
    ds_read_b64_tr_b16 v[30:31], v219 offset:20992
    ds_read_b64_tr_b16 v[32:33], v219 offset:28672
    ds_read_b64_tr_b16 v[34:35], v219 offset:29184
    ds_read_b64_tr_b16 v[36:37], v219 offset:36864
    ds_read_b64_tr_b16 v[38:39], v219 offset:37376
L_cs_1:
    s_add_u32 m0, s74, 81920
    s_xor_b32 s61, s66, 2
    s_add_u32 s61, s61, s67
    s_and_b32 s61, s61, 7
    s_lshl_b32 s70, s61, 7
    s_mul_i32 s61, s61, s64
    s_add_u32 s68, s70, s78
    buffer_load_dwordx4 v208, s[28:31], s68 offen  lds
    s_addk_i32 m0, 1024
    s_nop 0
    buffer_load_dwordx4 v209, s[28:31], s68 offen  lds
    s_bitcmp1_b32 s48, 2
    s_cbranch_scc1 L_cs_2
    s_waitcnt lgkmcnt(0)
    v_mfma_f32_16x16x32_bf16 v[44:47], v[56:59], v[12:15], 0
    v_mfma_f32_16x16x32_bf16 v[48:51], v[56:59], v[16:19], 0
    v_mfma_f32_16x16x32_bf16 v[52:55], v[56:59], v[20:23], 0
    v_mfma_f32_16x16x32_bf16 v[44:47], v[56:59], v[28:31], v[44:47]
    v_mfma_f32_16x16x32_bf16 v[48:51], v[56:59], v[32:35], v[48:51]
    v_mfma_f32_16x16x32_bf16 v[52:55], v[56:59], v[36:39], v[52:55]
L_cs_2:
    s_add_u32 m0, s76, 98304
    s_add_u32 s69, s61, s80
    buffer_load_dwordx4 v210, s[32:35], s69 offen  lds
    s_addk_i32 m0, 8192
    s_add_u32 s69, s69, s65
    buffer_load_dwordx4 v210, s[32:35], s69 offen  lds
    s_addk_i32 m0, 8192
    s_add_u32 s69, s69, s65
    buffer_load_dwordx4 v211, s[32:35], s69 offen  lds
    s_waitcnt vmcnt(5)
    s_barrier
    s_add_u32 m0, s75, 81920
    s_add_u32 s68, s70, s79
    buffer_load_dwordx4 v208, s[28:31], s68 offen  lds
    s_addk_i32 m0, 1024
    s_nop 0
    buffer_load_dwordx4 v209, s[28:31], s68 offen  lds
    s_add_u32 m0, s77, 98304
    s_add_u32 s69, s61, s81
    buffer_load_dwordx4 v212, s[32:35], s69 offen  lds
    s_addk_i32 m0, 8192
    s_add_u32 s69, s69, s65
    buffer_load_dwordx4 v212, s[32:35], s69 offen  lds
    s_addk_i32 m0, 8192
    s_add_u32 s69, s69, s65
    buffer_load_dwordx4 v213, s[32:35], s69 offen  lds
    buffer_load_dwordx4 v[198:201], v214, s[28:31], s55 offen
    buffer_load_dwordx4 v[202:205], v214, s[28:31], s55 offen offset:512
    buffer_load_dword v255, v215, s[40:43], s54 offen
    s_add_u32 m0, s74, 0
    s_xor_b32 s61, s66, 3
    s_add_u32 s61, s61, s67
    s_and_b32 s61, s61, 7
    s_lshl_b32 s70, s61, 7
    s_mul_i32 s61, s61, s64
    s_add_u32 s68, s70, s78
    buffer_load_dwordx4 v208, s[28:31], s68 offen  lds
    s_addk_i32 m0, 1024
    s_nop 0
    buffer_load_dwordx4 v209, s[28:31], s68 offen  lds
    s_bitcmp1_b32 s48, 2
    s_cbranch_scc1 L_cs_3
    ds_read_b64_tr_b16 v[12:13], v220 offset:16384
    ds_read_b64_tr_b16 v[14:15], v220 offset:16896
    ds_read_b64_tr_b16 v[16:17], v220 offset:24576
    ds_read_b64_tr_b16 v[18:19], v220 offset:25088
    ds_read_b64_tr_b16 v[20:21], v220 offset:32768
    ds_read_b64_tr_b16 v[22:23], v220 offset:33280
    ds_read_b64_tr_b16 v[28:29], v220 offset:20480
    ds_read_b64_tr_b16 v[30:31], v220 offset:20992
    ds_read_b64_tr_b16 v[32:33], v220 offset:28672
    ds_read_b64_tr_b16 v[34:35], v220 offset:29184
    ds_read_b64_tr_b16 v[36:37], v220 offset:36864
    ds_read_b64_tr_b16 v[38:39], v220 offset:37376
L_cs_3:
    s_add_u32 m0, s76, 16384
    s_add_u32 s69, s61, s80
    buffer_load_dwordx4 v210, s[32:35], s69 offen  lds
    s_addk_i32 m0, 8192
    s_add_u32 s69, s69, s65
    buffer_load_dwordx4 v210, s[32:35], s69 offen  lds
    s_addk_i32 m0, 8192
    s_add_u32 s69, s69, s65
    buffer_load_dwordx4 v211, s[32:35], s69 offen  lds
    s_add_u32 m0, s75, 0
    s_add_u32 s68, s70, s79
    buffer_load_dwordx4 v208, s[28:31], s68 offen  lds
    s_addk_i32 m0, 1024
    s_nop 0
    buffer_load_dwordx4 v209, s[28:31], s68 offen  lds
    s_bitcmp1_b32 s48, 2
    s_cbranch_scc1 L_cs_4
    s_waitcnt lgkmcnt(0)
    v_mfma_f32_16x16x32_bf16 v[44:47], v[56:59], v[12:15], v[44:47]
    v_mfma_f32_16x16x32_bf16 v[48:51], v[56:59], v[16:19], v[48:51]
    v_mfma_f32_16x16x32_bf16 v[52:55], v[56:59], v[20:23], v[52:55]
    v_mfma_f32_16x16x32_bf16 v[44:47], v[56:59], v[28:31], v[44:47]
    v_mfma_f32_16x16x32_bf16 v[48:51], v[56:59], v[32:35], v[48:51]
    v_mfma_f32_16x16x32_bf16 v[52:55], v[56:59], v[36:39], v[52:55]
L_cs_4:
    s_add_u32 m0, s77, 16384
    s_add_u32 s69, s61, s81
    buffer_load_dwordx4 v212, s[32:35], s69 offen  lds
    s_waitcnt vmcnt(11)
    s_barrier
    s_branch L_B2
L_A:
    s_setprio 2
    v_lshrrev_b32 v3, 4, v1
    v_cmp_gt_u32 vcc, 8, v1
    v_lshrrev_b32 v5, 3, v1
    v_and_b32 v6, 7, v1
    v_lshlrev_b32 v6, 4, v6
    v_lshl_add_u32 v130, v5, 18, v6
    v_mov_b32 v7, 1073741824
    v_lshlrev_b32 v4, 3, v3
    v_cndmask_b32 v130, v7, v130, vcc
    v_min_u32 v5, 0, v1
    v_lshlrev_b32 v6, 17, v5
    v_lshlrev_b32 v5, 18, v5
    v_lshlrev_b32 v129, 4, v1
    s_add_u32 s56, s51, s45
    s_lshl_b32 s56, s56, 5
    s_lshl2_add_u32 s74, s49, s45
    s_lshl4_add_u32 s75, s74, s48
    s_lshl4_add_u32 s72, s48, s53
    s_lshl2_add_u32 s72, s72, s45
    s_lshl_b32 s72, s72, 8
    s_add_u32 s72, s72, 12222464
    s_lshl_b32 s73, s75, 8
    s_add_u32 s73, s73, 14319616
    s_lshl_b32 s57, s47, 5
    s_add_u32 s57, s57, s46
    s_lshl2_add_u32 s57, s57, s45
    s_lshl_b32 s57, s57, 8
    s_add_u32 s57, s57, 12222464
    s_mov_b32 s42, 15368320
    s_mov_b32 s43, 0x20000
    s_mov_b32 s30, 2752
    s_mov_b32 s31, 0x20000
    s_cmp_eq_u32 s50, 0
    s_waitcnt lgkmcnt(0)
    s_mov_b64 s[40:41], s[24:25]
    s_mov_b64 s[28:29], s[14:15]
    buffer_load_dword v255, v5, s[40:43], s72 offen
    s_cbranch_scc1 L_A1
    buffer_load_dwordx2 v[120:121], v4, s[28:31], s56 offen offset:0
    buffer_load_dwordx2 v[122:123], v4, s[28:31], s56 offen offset:128
    buffer_load_dwordx2 v[124:125], v4, s[28:31], s56 offen offset:256
    s_branch L_A2
L_A1:
    buffer_load_dword v255, v6, s[40:43], s73 offen
L_A2:
    s_setprio 0
    s_add_u32 s62, s24, 15368192
    s_addc_u32 s63, s25, 0
    s_load_dwordx2 s[26:27], s[62:63], 0
    v_mov_b64 v[8:9], 0
    v_mov_b64 v[10:11], 0
    v_mov_b64 v[12:13], 0
    v_mov_b64 v[14:15], 0
    v_mov_b64 v[16:17], 0
    v_mov_b64 v[18:19], 0
    v_mov_b64 v[20:21], 0
    v_mov_b64 v[22:23], 0
    v_mov_b64 v[24:25], 0
    v_mov_b64 v[26:27], 0
    v_mov_b64 v[28:29], 0
    v_mov_b64 v[30:31], 0
    v_mov_b64 v[32:33], 0
    v_mov_b64 v[34:35], 0
    v_mov_b64 v[36:37], 0
    v_mov_b64 v[38:39], 0
    v_mov_b64 v[40:41], 0
    v_mov_b64 v[42:43], 0
    v_mov_b64 v[44:45], 0
    v_mov_b64 v[46:47], 0
    v_mov_b64 v[48:49], 0
    v_mov_b64 v[50:51], 0
    v_mov_b64 v[52:53], 0
    v_mov_b64 v[54:55], 0
    v_mov_b64 v[56:57], 0
    v_mov_b64 v[58:59], 0
    v_mov_b64 v[60:61], 0
    v_mov_b64 v[62:63], 0
    v_mov_b64 v[64:65], 0
    v_mov_b64 v[66:67], 0
    v_mov_b64 v[68:69], 0
    v_mov_b64 v[70:71], 0
    v_mov_b64 v[72:73], 0
    v_mov_b64 v[74:75], 0
    v_mov_b64 v[76:77], 0
    v_mov_b64 v[78:79], 0
    v_mov_b64 v[80:81], 0
    v_mov_b64 v[82:83], 0
    v_mov_b64 v[84:85], 0
    v_mov_b64 v[86:87], 0
    v_mov_b64 v[88:89], 0
    v_mov_b64 v[90:91], 0
    v_mov_b64 v[92:93], 0
    v_mov_b64 v[94:95], 0
    v_mov_b64 v[96:97], 0
    v_mov_b64 v[98:99], 0
    v_mov_b64 v[100:101], 0
    v_mov_b64 v[102:103], 0
    v_mov_b32 v116, 0x3f803f80
    v_mov_b32 v117, 0x3f803f80
    v_mov_b32 v118, 0x3f803f80
    v_mov_b32 v119, 0x3f803f80
    v_lshrrev_b32 v3, 4, v1
    v_bfe_u32 v4, v1, 2, 2
    v_lshl_add_u32 v5, v3, 3, v4
    v_lshlrev_b32 v5, 7, v5
    v_bfe_u32 v4, v1, 3, 2
    v_xor_b32 v4, s45, v4
    v_lshl_add_u32 v5, v4, 5, v5
    v_and_b32 v4, 3, v1
    v_lshl_add_u32 v128, v4, 3, v5
    v_and_b32 v2, 15, v1
    v_lshrrev_b32 v4, 1, v2
    v_xor_b32 v4, v4, v3
    v_lshlrev_b32 v4, 4, v4
    v_lshl_add_u32 v126, v2, 7, v4
    v_xor_b32 v127, 64, v126
    v_mul_u32_u24 v4, 43, v1
    v_lshrrev_b32 v4, 10, v4
    v_lshl_add_u32 v4, v4, 3, v1
    v_lshlrev_b32 v131, 4, v4
    s_mov_b32 s68, 0x358637bd
    s_mov_b32 s69, 0x358637bd
    s_mov_b32 s70, 0x3fb8aa3b
    s_mov_b32 s71, 0x3fb8aa3b
    s_mov_b32 s66, 40960
    s_barrier
    s_waitcnt lgkmcnt(0)
    s_add_u32 s26, s26, 0x7f4a7c15
    s_add_u32 s27, s27, 0x9e3779b9
    v_mov_b32 v0, 142336
    v_lshlrev_b32 v6, 3, v2
    v_add_u32 v6, 131072, v6
    s_lshl_b32 s56, s45, 6
    s_add_u32 s56, s56, 141312
    v_lshl_add_u32 v7, v3, 4, s56
    s_cmp_eq_u32 s50, 0
    s_cbranch_scc1 L_Aq
    s_waitcnt vmcnt(0)
    s_mul_i32 s56, s48, 236
    s_add_u32 s56, s56, s51
    s_add_u32 s56, s56, s45
    s_mul_i32 s56, s56, 3072
    s_add_u32 s57, s56, 362496
    s_mov_b32 s3, 0
    s_mov_b32 s65, 0
    s_add_u32 s58, s45, 8
    s_cmp_ge_u32 s58, s52
    s_cselect_b64 vcc, -1, 0
    v_mov_b64 v[212:213], 0
    v_mov_b64 v[214:215], 0
    v_mov_b64 v[216:217], 0
    v_mov_b64 v[218:219], 0
    s_barrier
    ds_read_b64_tr_b16 v[228:229], v128 offset:16384
    ds_read_b64_tr_b16 v[230:231], v128 offset:16896
    ds_read_b64_tr_b16 v[232:233], v128 offset:20480
    ds_read_b64_tr_b16 v[234:235], v128 offset:20992
    ds_read_b64_tr_b16 v[236:237], v128 offset:24576
    ds_read_b64_tr_b16 v[238:239], v128 offset:25088
    ds_read_b64_tr_b16 v[240:241], v128 offset:28672
    ds_read_b64_tr_b16 v[242:243], v128 offset:29184
    ds_read_b64_tr_b16 v[244:245], v128 offset:32768
    ds_read_b64_tr_b16 v[246:247], v128 offset:33280
    ds_read_b64_tr_b16 v[248:249], v128 offset:36864
    ds_read_b64_tr_b16 v[250:251], v128 offset:37376
    ds_read_b128 v[132:135], v126 offset:0
    ds_read_b128 v[136:139], v127 offset:0
    ds_read_b128 v[140:143], v126 offset:2048
    ds_read_b128 v[144:147], v127 offset:2048
    ds_read_b128 v[148:151], v126 offset:4096
    ds_read_b128 v[152:155], v127 offset:4096
    ds_read_b128 v[156:159], v126 offset:6144
    ds_read_b128 v[160:163], v127 offset:6144
    s_waitcnt lgkmcnt(0)
.p2align 3
L_loopH:
    v_mfma_f32_16x16x32_bf16 v[8:11], v[228:231], v[132:135], v[8:11]
    ds_read_b128 v[164:167], v126 offset:8192
    v_mfma_f32_16x16x32_bf16 v[8:11], v[232:235], v[136:139], v[8:11]
    ds_read_b128 v[168:171], v127 offset:8192
    v_mfma_f32_16x16x32_bf16 v[40:43], v[236:239], v[132:135], v[40:43]
    ds_read_b128 v[172:175], v126 offset:10240
    v_mfma_f32_16x16x32_bf16 v[40:43], v[240:243], v[136:139], v[40:43]
    ds_read_b128 v[176:179], v127 offset:10240
    v_mfma_f32_16x16x32_bf16 v[44:47], v[236:239], v[140:143], v[44:47]
    ds_read_b128 v[180:183], v126 offset:12288
    v_mfma_f32_16x16x32_bf16 v[44:47], v[240:243], v[144:147], v[44:47]
    ds_read_b128 v[184:187], v127 offset:12288
    v_mfma_f32_16x16x32_bf16 v[12:15], v[228:231], v[140:143], v[12:15]
    ds_read_b128 v[188:191], v126 offset:14336
    v_mfma_f32_16x16x32_bf16 v[12:15], v[232:235], v[144:147], v[12:15]
    ds_read_b128 v[192:195], v127 offset:14336
    v_mfma_f32_16x16x32_bf16 v[16:19], v[228:231], v[148:151], v[16:19]
    s_add_u32 s65, s65, 1
    s_cmp_eq_u32 s65, 3
    v_mfma_f32_16x16x32_bf16 v[16:19], v[232:235], v[152:155], v[16:19]
    s_cselect_b32 s64, 4294885376, s66
    v_mfma_f32_16x16x32_bf16 v[48:51], v[236:239], v[148:151], v[48:51]
    s_cselect_b32 s65, 0, s65
    s_add_u32 s3, s3, 1
    v_mfma_f32_16x16x32_bf16 v[48:51], v[240:243], v[152:155], v[48:51]
    v_add_u32 v126, s64, v126
    s_cmp_eq_u32 s3, 8
    v_mfma_f32_16x16x32_bf16 v[52:55], v[236:239], v[156:159], v[52:55]
    v_add_u32_e64 v127, s64, v127
    v_mfma_f32_16x16x32_bf16 v[52:55], v[240:243], v[160:163], v[52:55]
    v_add_u32_e64 v128, s64, v128
    v_mfma_f32_16x16x32_bf16 v[20:23], v[228:231], v[156:159], v[20:23]
    v_mfma_f32_16x16x32_bf16 v[20:23], v[232:235], v[160:163], v[20:23]
    s_cbranch_vccnz L_zs_21
    s_nop 0
    v_mfma_f32_16x16x32_bf16 v[84:87], v[244:247], v[156:159], v[84:87]
    v_mfma_f32_16x16x32_bf16 v[84:87], v[248:251], v[160:163], v[84:87]
    v_mfma_f32_16x16x32_bf16 v[80:83], v[244:247], v[148:151], v[80:83]
    v_mfma_f32_16x16x32_bf16 v[80:83], v[248:251], v[152:155], v[80:83]
    v_mfma_f32_16x16x32_bf16 v[76:79], v[244:247], v[140:143], v[76:79]
    v_mfma_f32_16x16x32_bf16 v[76:79], v[248:251], v[144:147], v[76:79]
L_zs_21:
    v_mfma_f32_16x16x32_bf16 v[72:75], v[244:247], v[132:135], v[72:75]
    s_waitcnt lgkmcnt(0)
    s_nop 0
    v_mfma_f32_16x16x32_bf16 v[72:75], v[248:251], v[136:139], v[72:75]
    s_nop 0
    s_barrier
    v_mfma_f32_16x16x32_bf16 v[24:27], v[228:231], v[164:167], v[24:27]
    ds_read_b128 v[132:135], v126 offset:0
    v_mfma_f32_16x16x32_bf16 v[24:27], v[232:235], v[168:171], v[24:27]
    ds_read_b128 v[136:139], v127 offset:0
    v_mfma_f32_16x16x32_bf16 v[56:59], v[236:239], v[164:167], v[56:59]
    ds_read_b64_tr_b16 v[196:197], v128 offset:16384
    v_mfma_f32_16x16x32_bf16 v[56:59], v[240:243], v[168:171], v[56:59]
    ds_read_b64_tr_b16 v[198:199], v128 offset:16896
    v_mfma_f32_16x16x32_bf16 v[60:63], v[236:239], v[172:175], v[60:63]
    ds_read_b64_tr_b16 v[200:201], v128 offset:20480
    v_mfma_f32_16x16x32_bf16 v[60:63], v[240:243], v[176:179], v[60:63]
    ds_read_b64_tr_b16 v[202:203], v128 offset:20992
    v_mfma_f32_16x16x32_bf16 v[28:31], v[228:231], v[172:175], v[28:31]
    ds_read_b64_tr_b16 v[204:205], v128 offset:24576
    v_mfma_f32_16x16x32_bf16 v[28:31], v[232:235], v[176:179], v[28:31]
    ds_read_b64_tr_b16 v[206:207], v128 offset:25088
    v_mfma_f32_16x16x32_bf16 v[32:35], v[228:231], v[180:183], v[32:35]
    ds_read_b64_tr_b16 v[208:209], v128 offset:28672
    v_mfma_f32_16x16x32_bf16 v[32:35], v[232:235], v[184:187], v[32:35]
    ds_read_b64_tr_b16 v[210:211], v128 offset:29184
    v_mfma_f32_16x16x32_bf16 v[64:67], v[236:239], v[180:183], v[64:67]
    ds_read_b128 v[140:143], v126 offset:2048
    v_mfma_f32_16x16x32_bf16 v[64:67], v[240:243], v[184:187], v[64:67]
    ds_read_b128 v[144:147], v127 offset:2048
    v_mfma_f32_16x16x32_bf16 v[68:71], v[236:239], v[188:191], v[68:71]
    ds_read_b128 v[148:151], v126 offset:4096
    v_mfma_f32_16x16x32_bf16 v[68:71], v[240:243], v[192:195], v[68:71]
    ds_read_b128 v[152:155], v127 offset:4096
    v_mfma_f32_16x16x32_bf16 v[36:39], v[228:231], v[188:191], v[36:39]
    ds_read_b128 v[156:159], v126 offset:6144
    v_mfma_f32_16x16x32_bf16 v[36:39], v[232:235], v[192:195], v[36:39]
    ds_read_b128 v[160:163], v127 offset:6144
    s_cbranch_vccnz L_zs_22
    v_mfma_f32_16x16x32_bf16 v[100:103], v[244:247], v[188:191], v[100:103]
    ds_read_b64_tr_b16 v[212:213], v128 offset:32768
    v_mfma_f32_16x16x32_bf16 v[100:103], v[248:251], v[192:195], v[100:103]
    ds_read_b64_tr_b16 v[214:215], v128 offset:33280
    v_mfma_f32_16x16x32_bf16 v[96:99], v[244:247], v[180:183], v[96:99]
    ds_read_b64_tr_b16 v[216:217], v128 offset:36864
    v_mfma_f32_16x16x32_bf16 v[96:99], v[248:251], v[184:187], v[96:99]
    ds_read_b64_tr_b16 v[218:219], v128 offset:37376
    v_mfma_f32_16x16x32_bf16 v[92:95], v[244:247], v[172:175], v[92:95]
    s_nop 0
    v_mfma_f32_16x16x32_bf16 v[92:95], v[248:251], v[176:179], v[92:95]
L_zs_22:
    v_mfma_f32_16x16x32_bf16 v[88:91], v[244:247], v[164:167], v[88:91]
    v_mfma_f32_16x16x32_bf16 v[88:91], v[248:251], v[168:171], v[88:91]
    s_waitcnt lgkmcnt(0)
    s_nop 0
    v_mfma_f32_16x16x32_bf16 v[8:11], v[196:199], v[132:135], v[8:11]
    ds_read_b128 v[164:167], v126 offset:8192
    v_mfma_f32_16x16x32_bf16 v[8:11], v[200:203], v[136:139], v[8:11]
    ds_read_b128 v[168:171], v127 offset:8192
    v_mfma_f32_16x16x32_bf16 v[40:43], v[204:207], v[132:135], v[40:43]
    ds_read_b128 v[172:175], v126 offset:10240
    v_mfma_f32_16x16x32_bf16 v[40:43], v[208:211], v[136:139], v[40:43]
    ds_read_b128 v[176:179], v127 offset:10240
    v_mfma_f32_16x16x32_bf16 v[44:47], v[204:207], v[140:143], v[44:47]
    ds_read_b128 v[180:183], v126 offset:12288
    v_mfma_f32_16x16x32_bf16 v[44:47], v[208:211], v[144:147], v[44:47]
    ds_read_b128 v[184:187], v127 offset:12288
    v_mfma_f32_16x16x32_bf16 v[12:15], v[196:199], v[140:143], v[12:15]
    ds_read_b128 v[188:191], v126 offset:14336
    v_mfma_f32_16x16x32_bf16 v[12:15], v[200:203], v[144:147], v[12:15]
    ds_read_b128 v[192:195], v127 offset:14336
    v_mfma_f32_16x16x32_bf16 v[16:19], v[196:199], v[148:151], v[16:19]
    s_add_u32 s65, s65, 1
    s_cmp_eq_u32 s65, 3
    v_mfma_f32_16x16x32_bf16 v[16:19], v[200:203], v[152:155], v[16:19]
    s_cselect_b32 s64, 4294885376, s66
    v_mfma_f32_16x16x32_bf16 v[48:51], v[204:207], v[148:151], v[48:51]
    s_cselect_b32 s65, 0, s65
    s_add_u32 s3, s3, 1
    v_mfma_f32_16x16x32_bf16 v[48:51], v[208:211], v[152:155], v[48:51]
    v_add_u32 v126, s64, v126
    s_cmp_eq_u32 s3, 8
    v_mfma_f32_16x16x32_bf16 v[52:55], v[204:207], v[156:159], v[52:55]
    v_add_u32_e64 v127, s64, v127
    v_mfma_f32_16x16x32_bf16 v[52:55], v[208:211], v[160:163], v[52:55]
    v_add_u32_e64 v128, s64, v128
    v_mfma_f32_16x16x32_bf16 v[20:23], v[196:199], v[156:159], v[20:23]
    v_mfma_f32_16x16x32_bf16 v[20:23], v[200:203], v[160:163], v[20:23]
    s_cbranch_vccnz L_zs_23
    s_nop 0
    v_mfma_f32_16x16x32_bf16 v[84:87], v[212:215], v[156:159], v[84:87]
    v_mfma_f32_16x16x32_bf16 v[84:87], v[216:219], v[160:163], v[84:87]
    v_mfma_f32_16x16x32_bf16 v[80:83], v[212:215], v[148:151], v[80:83]
    v_mfma_f32_16x16x32_bf16 v[80:83], v[216:219], v[152:155], v[80:83]
    v_mfma_f32_16x16x32_bf16 v[76:79], v[212:215], v[140:143], v[76:79]
    v_mfma_f32_16x16x32_bf16 v[76:79], v[216:219], v[144:147], v[76:79]
L_zs_23:
    v_mfma_f32_16x16x32_bf16 v[72:75], v[212:215], v[132:135], v[72:75]
    s_waitcnt lgkmcnt(0)
    s_nop 0
    v_mfma_f32_16x16x32_bf16 v[72:75], v[216:219], v[136:139], v[72:75]
    s_cbranch_scc1 L_tailH
    s_barrier
    v_mfma_f32_16x16x32_bf16 v[24:27], v[196:199], v[164:167], v[24:27]
    ds_read_b128 v[132:135], v126 offset:0
    v_mfma_f32_16x16x32_bf16 v[24:27], v[200:203], v[168:171], v[24:27]
    ds_read_b128 v[136:139], v127 offset:0
    v_mfma_f32_16x16x32_bf16 v[56:59], v[204:207], v[164:167], v[56:59]
    ds_read_b64_tr_b16 v[228:229], v128 offset:16384
    v_mfma_f32_16x16x32_bf16 v[56:59], v[208:211], v[168:171], v[56:59]
    ds_read_b64_tr_b16 v[230:231], v128 offset:16896
    v_mfma_f32_16x16x32_bf16 v[60:63], v[204:207], v[172:175], v[60:63]
    ds_read_b64_tr_b16 v[232:233], v128 offset:20480
    v_mfma_f32_16x16x32_bf16 v[60:63], v[208:211], v[176:179], v[60:63]
    ds_read_b64_tr_b16 v[234:235], v128 offset:20992
    v_mfma_f32_16x16x32_bf16 v[28:31], v[196:199], v[172:175], v[28:31]
    ds_read_b64_tr_b16 v[236:237], v128 offset:24576
    v_mfma_f32_16x16x32_bf16 v[28:31], v[200:203], v[176:179], v[28:31]
    ds_read_b64_tr_b16 v[238:239], v128 offset:25088
    v_mfma_f32_16x16x32_bf16 v[32:35], v[196:199], v[180:183], v[32:35]
    ds_read_b64_tr_b16 v[240:241], v128 offset:28672
    v_mfma_f32_16x16x32_bf16 v[32:35], v[200:203], v[184:187], v[32:35]
    ds_read_b64_tr_b16 v[242:243], v128 offset:29184
    v_mfma_f32_16x16x32_bf16 v[64:67], v[204:207], v[180:183], v[64:67]
    ds_read_b128 v[140:143], v126 offset:2048
    v_mfma_f32_16x16x32_bf16 v[64:67], v[208:211], v[184:187], v[64:67]
    ds_read_b128 v[144:147], v127 offset:2048
    v_mfma_f32_16x16x32_bf16 v[68:71], v[204:207], v[188:191], v[68:71]
    ds_read_b128 v[148:151], v126 offset:4096
    v_mfma_f32_16x16x32_bf16 v[68:71], v[208:211], v[192:195], v[68:71]
    ds_read_b128 v[152:155], v127 offset:4096
    v_mfma_f32_16x16x32_bf16 v[36:39], v[196:199], v[188:191], v[36:39]
    ds_read_b128 v[156:159], v126 offset:6144
    v_mfma_f32_16x16x32_bf16 v[36:39], v[200:203], v[192:195], v[36:39]
    ds_read_b128 v[160:163], v127 offset:6144
    s_cbranch_vccnz L_zs_24
    v_mfma_f32_16x16x32_bf16 v[100:103], v[212:215], v[188:191], v[100:103]
    ds_read_b64_tr_b16 v[244:245], v128 offset:32768
    v_mfma_f32_16x16x32_bf16 v[100:103], v[216:219], v[192:195], v[100:103]
    ds_read_b64_tr_b16 v[246:247], v128 offset:33280
    v_mfma_f32_16x16x32_bf16 v[96:99], v[212:215], v[180:183], v[96:99]
    ds_read_b64_tr_b16 v[248:249], v128 offset:36864
    v_mfma_f32_16x16x32_bf16 v[96:99], v[216:219], v[184:187], v[96:99]
    ds_read_b64_tr_b16 v[250:251], v128 offset:37376
    v_mfma_f32_16x16x32_bf16 v[92:95], v[212:215], v[172:175], v[92:95]
    s_nop 0
    v_mfma_f32_16x16x32_bf16 v[92:95], v[216:219], v[176:179], v[92:95]
L_zs_24:
    v_mfma_f32_16x16x32_bf16 v[88:91], v[212:215], v[164:167], v[88:91]
    v_mfma_f32_16x16x32_bf16 v[88:91], v[216:219], v[168:171], v[88:91]
    s_waitcnt lgkmcnt(0)
    s_branch L_loopH
.p2align 3
L_tailH:
    s_setprio 2
    s_nop 0
    v_mfma_f32_16x16x32_bf16 v[24:27], v[196:199], v[164:167], v[24:27]
    ds_read_b128 v[232:235], v0
    v_mfma_f32_16x16x32_bf16 v[24:27], v[200:203], v[168:171], v[24:27]
    ds_read_b128 v[104:107], v7 offset:0
    v_mfma_f32_16x16x32_bf16 v[28:31], v[196:199], v[172:175], v[28:31]
    ds_read_b128 v[108:111], v7 offset:256
    v_mfma_f32_16x16x32_bf16 v[28:31], v[200:203], v[176:179], v[28:31]
    ds_read_b128 v[112:115], v7 offset:512
    v_mfma_f32_16x16x32_bf16 v[32:35], v[196:199], v[180:183], v[32:35]
    ds_read_b64 v[132:133], v6 offset:0
    v_mfma_f32_16x16x32_bf16 v[32:35], v[200:203], v[184:187], v[32:35]
    ds_read_b64 v[134:135], v6 offset:128
    v_mfma_f32_16x16x32_bf16 v[36:39], v[196:199], v[188:191], v[36:39]
    ds_read_b64 v[136:137], v6 offset:256
    v_mfma_f32_16x16x32_bf16 v[36:39], v[200:203], v[192:195], v[36:39]
    ds_read_b64 v[138:139], v6 offset:384
    v_mfma_f32_16x16x32_bf16 v[56:59], v[204:207], v[164:167], v[56:59]
    ds_read_b64 v[140:141], v6 offset:512
    v_mfma_f32_16x16x32_bf16 v[56:59], v[208:211], v[168:171], v[56:59]
    ds_read_b64 v[142:143], v6 offset:640
    v_mfma_f32_16x16x32_bf16 v[60:63], v[204:207], v[172:175], v[60:63]
    ds_read_b64 v[144:145], v6 offset:768
    v_mfma_f32_16x16x32_bf16 v[60:63], v[208:211], v[176:179], v[60:63]
    ds_read_b64 v[146:147], v6 offset:896
    v_mfma_f32_16x16x32_bf16 v[64:67], v[204:207], v[180:183], v[64:67]
    v_lshlrev_b32_e64 v220, 16, v120
    v_mfma_f32_16x16x32_bf16 v[64:67], v[208:211], v[184:187], v[64:67]
    v_and_b32 v221, 0xffff0000, v120
    v_mfma_f32_16x16x32_bf16 v[68:71], v[204:207], v[188:191], v[68:71]
    v_lshlrev_b32_e64 v222, 16, v121
    v_mfma_f32_16x16x32_bf16 v[68:71], v[208:211], v[192:195], v[68:71]
    v_and_b32 v223, 0xffff0000, v121
    v_mfma_f32_16x16x32_bf16 v[88:91], v[212:215], v[164:167], v[88:91]
    v_lshlrev_b32_e64 v224, 16, v122
    v_mfma_f32_16x16x32_bf16 v[88:91], v[216:219], v[168:171], v[88:91]
    v_and_b32 v225, 0xffff0000, v122
    v_mfma_f32_16x16x32_bf16 v[92:95], v[212:215], v[172:175], v[92:95]
    v_lshlrev_b32_e64 v226, 16, v123
    v_mfma_f32_16x16x32_bf16 v[92:95], v[216:219], v[176:179], v[92:95]
    v_and_b32 v227, 0xffff0000, v123
    v_mfma_f32_16x16x32_bf16 v[96:99], v[212:215], v[180:183], v[96:99]
    v_lshlrev_b32_e64 v228, 16, v124
    v_mfma_f32_16x16x32_bf16 v[96:99], v[216:219], v[184:187], v[96:99]
    v_and_b32 v229, 0xffff0000, v124
    v_mfma_f32_16x16x32_bf16 v[100:103], v[212:215], v[188:191], v[100:103]
    v_lshlrev_b32_e64 v230, 16, v125
    v_mfma_f32_16x16x32_bf16 v[100:103], v[216:219], v[192:195], v[100:103]
    v_and_b32 v231, 0xffff0000, v125
    s_waitcnt lgkmcnt(0)
    v_min3_u32 v232, v232, v233, v234
    v_min_u32 v232, v232, v235
    v_cmp_ne_u32 vcc, 0, v232
    s_nop 0
    s_cmp_eq_u64 vcc, exec
    s_cbranch_scc0 L_nordyH
L_rdyH:
    s_add_u32 s54, s56, 12288
    s_add_u32 s55, s57, 12288
    s_add_u32 s60, s56, 24576
    s_add_u32 s61, s57, 24576
    v_pk_fma_f32 v[8:9], v[104:105], v[132:133], v[8:9] op_sel_hi:[1,0,1]
    v_pk_fma_f32 v[10:11], v[106:107], v[132:133], v[10:11] op_sel_hi:[1,0,1]
    v_pk_fma_f32 v[8:9], v[8:9], v[132:133], v[220:221] op_sel:[0,1,0]
    v_pk_fma_f32 v[10:11], v[10:11], v[132:133], v[222:223] op_sel:[0,1,0]
    v_max_f32 v8, 0, v8
    v_max_f32 v9, 0, v9
    v_max_f32 v10, 0, v10
    v_max_f32 v11, 0, v11
    v_pk_mul_f32 v[8:9], v[8:9], v[8:9]
    v_pk_mul_f32 v[10:11], v[10:11], v[10:11]
    v_cvt_pk_bf16_f32 v164, v8, v9
    v_cvt_pk_bf16_f32 v165, v10, v11
    v_pk_fma_f32 v[12:13], v[104:105], v[134:135], v[12:13] op_sel_hi:[1,0,1]
    v_pk_fma_f32 v[14:15], v[106:107], v[134:135], v[14:15] op_sel_hi:[1,0,1]
    v_pk_fma_f32 v[12:13], v[12:13], v[134:135], v[220:221] op_sel:[0,1,0]
    v_pk_fma_f32 v[14:15], v[14:15], v[134:135], v[222:223] op_sel:[0,1,0]
    v_max_f32 v12, 0, v12
    v_max_f32 v13, 0, v13
    v_max_f32 v14, 0, v14
    v_max_f32 v15, 0, v15
    v_pk_mul_f32 v[12:13], v[12:13], v[12:13]
    v_pk_mul_f32 v[14:15], v[14:15], v[14:15]
    v_cvt_pk_bf16_f32 v166, v12, v13
    v_cvt_pk_bf16_f32 v167, v14, v15
    v_pk_fma_f32 v[16:17], v[104:105], v[136:137], v[16:17] op_sel_hi:[1,0,1]
    v_pk_fma_f32 v[18:19], v[106:107], v[136:137], v[18:19] op_sel_hi:[1,0,1]
    v_permlane16_swap_b32 v164, v166
    v_permlane16_swap_b32 v165, v167
    buffer_store_dwordx4 v[164:167], v131, s[40:43], s56 offen offset:0 sc1
    v_pk_fma_f32 v[16:17], v[16:17], v[136:137], v[220:221] op_sel:[0,1,0]
    v_pk_fma_f32 v[18:19], v[18:19], v[136:137], v[222:223] op_sel:[0,1,0]
    v_max_f32 v16, 0, v16
    v_max_f32 v17, 0, v17
    v_max_f32 v18, 0, v18
    v_max_f32 v19, 0, v19
    v_pk_mul_f32 v[16:17], v[16:17], v[16:17]
    v_pk_mul_f32 v[18:19], v[18:19], v[18:19]
    v_cvt_pk_bf16_f32 v168, v16, v17
    v_cvt_pk_bf16_f32 v169, v18, v19
    v_pk_fma_f32 v[20:21], v[104:105], v[138:139], v[20:21] op_sel_hi:[1,0,1]
    v_pk_fma_f32 v[22:23], v[106:107], v[138:139], v[22:23] op_sel_hi:[1,0,1]
    v_pk_fma_f32 v[20:21], v[20:21], v[138:139], v[220:221] op_sel:[0,1,0]
    v_pk_fma_f32 v[22:23], v[22:23], v[138:139], v[222:223] op_sel:[0,1,0]
    v_max_f32 v20, 0, v20
    v_max_f32 v21, 0, v21
    v_max_f32 v22, 0, v22
    v_max_f32 v23, 0, v23
    v_pk_mul_f32 v[20:21], v[20:21], v[20:21]
    v_pk_mul_f32 v[22:23], v[22:23], v[22:23]
    v_cvt_pk_bf16_f32 v170, v20, v21
    v_cvt_pk_bf16_f32 v171, v22, v23
    v_pk_fma_f32 v[24:25], v[104:105], v[140:141], v[24:25] op_sel_hi:[1,0,1]
    v_pk_fma_f32 v[26:27], v[106:107], v[140:141], v[26:27] op_sel_hi:[1,0,1]
    v_permlane16_swap_b32 v168, v170
    v_permlane16_swap_b32 v169, v171
    buffer_store_dwordx4 v[168:171], v131, s[40:43], s56 offen offset:1536 sc1
    v_pk_fma_f32 v[24:25], v[24:25], v[140:141], v[220:221] op_sel:[0,1,0]
    v_pk_fma_f32 v[26:27], v[26:27], v[140:141], v[222:223] op_sel:[0,1,0]
    v_max_f32 v24, 0, v24
    v_max_f32 v25, 0, v25
    v_max_f32 v26, 0, v26
    v_max_f32 v27, 0, v27
    v_pk_mul_f32 v[24:25], v[24:25], v[24:25]
    v_pk_mul_f32 v[26:27], v[26:27], v[26:27]
    v_cvt_pk_bf16_f32 v172, v24, v25
    v_cvt_pk_bf16_f32 v173, v26, v27
    v_pk_fma_f32 v[28:29], v[104:105], v[142:143], v[28:29] op_sel_hi:[1,0,1]
    v_pk_fma_f32 v[30:31], v[106:107], v[142:143], v[30:31] op_sel_hi:[1,0,1]
    v_pk_fma_f32 v[28:29], v[28:29], v[142:143], v[220:221] op_sel:[0,1,0]
    v_pk_fma_f32 v[30:31], v[30:31], v[142:143], v[222:223] op_sel:[0,1,0]
    v_max_f32 v28, 0, v28
    v_max_f32 v29, 0, v29
    v_max_f32 v30, 0, v30
    v_max_f32 v31, 0, v31
    v_pk_mul_f32 v[28:29], v[28:29], v[28:29]
    v_pk_mul_f32 v[30:31], v[30:31], v[30:31]
    v_cvt_pk_bf16_f32 v174, v28, v29
    v_cvt_pk_bf16_f32 v175, v30, v31
    v_pk_fma_f32 v[32:33], v[104:105], v[144:145], v[32:33] op_sel_hi:[1,0,1]
    v_pk_fma_f32 v[34:35], v[106:107], v[144:145], v[34:35] op_sel_hi:[1,0,1]
    v_permlane16_swap_b32 v172, v174
    v_permlane16_swap_b32 v173, v175
    buffer_store_dwordx4 v[172:175], v131, s[40:43], s57 offen offset:0 sc1
    v_pk_fma_f32 v[32:33], v[32:33], v[144:145], v[220:221] op_sel:[0,1,0]
    v_pk_fma_f32 v[34:35], v[34:35], v[144:145], v[222:223] op_sel:[0,1,0]
    v_max_f32 v32, 0, v32
    v_max_f32 v33, 0, v33
    v_max_f32 v34, 0, v34
    v_max_f32 v35, 0, v35
    v_pk_mul_f32 v[32:33], v[32:33], v[32:33]
    v_pk_mul_f32 v[34:35], v[34:35], v[34:35]
    v_cvt_pk_bf16_f32 v176, v32, v33
    v_cvt_pk_bf16_f32 v177, v34, v35
    v_pk_fma_f32 v[36:37], v[104:105], v[146:147], v[36:37] op_sel_hi:[1,0,1]
    v_pk_fma_f32 v[38:39], v[106:107], v[146:147], v[38:39] op_sel_hi:[1,0,1]
    v_pk_fma_f32 v[36:37], v[36:37], v[146:147], v[220:221] op_sel:[0,1,0]
    v_pk_fma_f32 v[38:39], v[38:39], v[146:147], v[222:223] op_sel:[0,1,0]
    v_max_f32 v36, 0, v36
    v_max_f32 v37, 0, v37
    v_max_f32 v38, 0, v38
    v_max_f32 v39, 0, v39
    v_pk_mul_f32 v[36:37], v[36:37], v[36:37]
    v_pk_mul_f32 v[38:39], v[38:39], v[38:39]
    v_cvt_pk_bf16_f32 v178, v36, v37
    v_cvt_pk_bf16_f32 v179, v38, v39
    v_pk_fma_f32 v[40:41], v[108:109], v[132:133], v[40:41] op_sel_hi:[1,0,1]
    v_pk_fma_f32 v[42:43], v[110:111], v[132:133], v[42:43] op_sel_hi:[1,0,1]
    v_permlane16_swap_b32 v176, v178
    v_permlane16_swap_b32 v177, v179
    buffer_store_dwordx4 v[176:179], v131, s[40:43], s57 offen offset:1536 sc1
    v_pk_fma_f32 v[40:41], v[40:41], v[132:133], v[224:225] op_sel:[0,1,0]
    v_pk_fma_f32 v[42:43], v[42:43], v[132:133], v[226:227] op_sel:[0,1,0]
    v_max_f32 v40, 0, v40
    v_max_f32 v41, 0, v41
    v_max_f32 v42, 0, v42
    v_max_f32 v43, 0, v43
    v_pk_mul_f32 v[40:41], v[40:41], v[40:41]
    v_pk_mul_f32 v[42:43], v[42:43], v[42:43]
    v_cvt_pk_bf16_f32 v180, v40, v41
    v_cvt_pk_bf16_f32 v181, v42, v43
    v_pk_fma_f32 v[44:45], v[108:109], v[134:135], v[44:45] op_sel_hi:[1,0,1]
    v_pk_fma_f32 v[46:47], v[110:111], v[134:135], v[46:47] op_sel_hi:[1,0,1]
    v_pk_fma_f32 v[44:45], v[44:45], v[134:135], v[224:225] op_sel:[0,1,0]
    v_pk_fma_f32 v[46:47], v[46:47], v[134:135], v[226:227] op_sel:[0,1,0]
    v_max_f32 v44, 0, v44
    v_max_f32 v45, 0, v45
    v_max_f32 v46, 0, v46
    v_max_f32 v47, 0, v47
    v_pk_mul_f32 v[44:45], v[44:45], v[44:45]
    v_pk_mul_f32 v[46:47], v[46:47], v[46:47]
    v_cvt_pk_bf16_f32 v182, v44, v45
    v_cvt_pk_bf16_f32 v183, v46, v47
    v_pk_fma_f32 v[48:49], v[108:109], v[136:137], v[48:49] op_sel_hi:[1,0,1]
    v_pk_fma_f32 v[50:51], v[110:111], v[136:137], v[50:51] op_sel_hi:[1,0,1]
    v_permlane16_swap_b32 v180, v182
    v_permlane16_swap_b32 v181, v183
    buffer_store_dwordx4 v[180:183], v131, s[40:43], s54 offen offset:0 sc1
    v_pk_fma_f32 v[48:49], v[48:49], v[136:137], v[224:225] op_sel:[0,1,0]
    v_pk_fma_f32 v[50:51], v[50:51], v[136:137], v[226:227] op_sel:[0,1,0]
    v_max_f32 v48, 0, v48
    v_max_f32 v49, 0, v49
    v_max_f32 v50, 0, v50
    v_max_f32 v51, 0, v51
    v_pk_mul_f32 v[48:49], v[48:49], v[48:49]
    v_pk_mul_f32 v[50:51], v[50:51], v[50:51]
    v_cvt_pk_bf16_f32 v184, v48, v49
    v_cvt_pk_bf16_f32 v185, v50, v51
    v_pk_fma_f32 v[52:53], v[108:109], v[138:139], v[52:53] op_sel_hi:[1,0,1]
    v_pk_fma_f32 v[54:55], v[110:111], v[138:139], v[54:55] op_sel_hi:[1,0,1]
    v_pk_fma_f32 v[52:53], v[52:53], v[138:139], v[224:225] op_sel:[0,1,0]
    v_pk_fma_f32 v[54:55], v[54:55], v[138:139], v[226:227] op_sel:[0,1,0]
    v_max_f32 v52, 0, v52
    v_max_f32 v53, 0, v53
    v_max_f32 v54, 0, v54
    v_max_f32 v55, 0, v55
    v_pk_mul_f32 v[52:53], v[52:53], v[52:53]
    v_pk_mul_f32 v[54:55], v[54:55], v[54:55]
    v_cvt_pk_bf16_f32 v186, v52, v53
    v_cvt_pk_bf16_f32 v187, v54, v55
    v_pk_fma_f32 v[56:57], v[108:109], v[140:141], v[56:57] op_sel_hi:[1,0,1]
    v_pk_fma_f32 v[58:59], v[110:111], v[140:141], v[58:59] op_sel_hi:[1,0,1]
    v_permlane16_swap_b32 v184, v186
    v_permlane16_swap_b32 v185, v187
    buffer_store_dwordx4 v[184:187], v131, s[40:43], s54 offen offset:1536 sc1
    v_pk_fma_f32 v[56:57], v[56:57], v[140:141], v[224:225] op_sel:[0,1,0]
    v_pk_fma_f32 v[58:59], v[58:59], v[140:141], v[226:227] op_sel:[0,1,0]
    v_max_f32 v56, 0, v56
    v_max_f32 v57, 0, v57
    v_max_f32 v58, 0, v58
    v_max_f32 v59, 0, v59
    v_pk_mul_f32 v[56:57], v[56:57], v[56:57]
    v_pk_mul_f32 v[58:59], v[58:59], v[58:59]
    v_cvt_pk_bf16_f32 v188, v56, v57
    v_cvt_pk_bf16_f32 v189, v58, v59
    v_pk_fma_f32 v[60:61], v[108:109], v[142:143], v[60:61] op_sel_hi:[1,0,1]
    v_pk_fma_f32 v[62:63], v[110:111], v[142:143], v[62:63] op_sel_hi:[1,0,1]
    v_pk_fma_f32 v[60:61], v[60:61], v[142:143], v[224:225] op_sel:[0,1,0]
    v_pk_fma_f32 v[62:63], v[62:63], v[142:143], v[226:227] op_sel:[0,1,0]
    v_max_f32 v60, 0, v60
    v_max_f32 v61, 0, v61
    v_max_f32 v62, 0, v62
    v_max_f32 v63, 0, v63
    v_pk_mul_f32 v[60:61], v[60:61], v[60:61]
    v_pk_mul_f32 v[62:63], v[62:63], v[62:63]
    v_cvt_pk_bf16_f32 v190, v60, v61
    v_cvt_pk_bf16_f32 v191, v62, v63
    v_pk_fma_f32 v[64:65], v[108:109], v[144:145], v[64:65] op_sel_hi:[1,0,1]
    v_pk_fma_f32 v[66:67], v[110:111], v[144:145], v[66:67] op_sel_hi:[1,0,1]
    v_permlane16_swap_b32 v188, v190
    v_permlane16_swap_b32 v189, v191
    buffer_store_dwordx4 v[188:191], v131, s[40:43], s55 offen offset:0 sc1
    v_pk_fma_f32 v[64:65], v[64:65], v[144:145], v[224:225] op_sel:[0,1,0]
    v_pk_fma_f32 v[66:67], v[66:67], v[144:145], v[226:227] op_sel:[0,1,0]
    v_max_f32 v64, 0, v64
    v_max_f32 v65, 0, v65
    v_max_f32 v66, 0, v66
    v_max_f32 v67, 0, v67
    v_pk_mul_f32 v[64:65], v[64:65], v[64:65]
    v_pk_mul_f32 v[66:67], v[66:67], v[66:67]
    v_cvt_pk_bf16_f32 v192, v64, v65
    v_cvt_pk_bf16_f32 v193, v66, v67
    v_pk_fma_f32 v[68:69], v[108:109], v[146:147], v[68:69] op_sel_hi:[1,0,1]
    v_pk_fma_f32 v[70:71], v[110:111], v[146:147], v[70:71] op_sel_hi:[1,0,1]
    v_pk_fma_f32 v[68:69], v[68:69], v[146:147], v[224:225] op_sel:[0,1,0]
    v_pk_fma_f32 v[70:71], v[70:71], v[146:147], v[226:227] op_sel:[0,1,0]
    v_max_f32 v68, 0, v68
    v_max_f32 v69, 0, v69
    v_max_f32 v70, 0, v70
    v_max_f32 v71, 0, v71
    v_pk_mul_f32 v[68:69], v[68:69], v[68:69]
    v_pk_mul_f32 v[70:71], v[70:71], v[70:71]
    v_cvt_pk_bf16_f32 v194, v68, v69
    v_cvt_pk_bf16_f32 v195, v70, v71
    s_add_u32 s58, s45, 8
    s_cmp_ge_u32 s58, s52
    v_permlane16_swap_b32 v192, v194
    v_permlane16_swap_b32 v193, v195
    buffer_store_dwordx4 v[192:195], v131, s[40:43], s55 offen offset:1536 sc1
    s_cbranch_scc1 L_Hdone
    v_pk_fma_f32 v[72:73], v[112:113], v[132:133], v[72:73] op_sel_hi:[1,0,1]
    v_pk_fma_f32 v[74:75], v[114:115], v[132:133], v[74:75] op_sel_hi:[1,0,1]
    v_pk_fma_f32 v[72:73], v[72:73], v[132:133], v[228:229] op_sel:[0,1,0]
    v_pk_fma_f32 v[74:75], v[74:75], v[132:133], v[230:231] op_sel:[0,1,0]
    v_max_f32 v72, 0, v72
    v_max_f32 v73, 0, v73
    v_max_f32 v74, 0, v74
    v_max_f32 v75, 0, v75
    v_pk_mul_f32 v[72:73], v[72:73], v[72:73]
    v_pk_mul_f32 v[74:75], v[74:75], v[74:75]
    v_cvt_pk_bf16_f32 v148, v72, v73
    v_cvt_pk_bf16_f32 v149, v74, v75
    v_pk_fma_f32 v[76:77], v[112:113], v[134:135], v[76:77] op_sel_hi:[1,0,1]
    v_pk_fma_f32 v[78:79], v[114:115], v[134:135], v[78:79] op_sel_hi:[1,0,1]
    v_pk_fma_f32 v[76:77], v[76:77], v[134:135], v[228:229] op_sel:[0,1,0]
    v_pk_fma_f32 v[78:79], v[78:79], v[134:135], v[230:231] op_sel:[0,1,0]
    v_max_f32 v76, 0, v76
    v_max_f32 v77, 0, v77
    v_max_f32 v78, 0, v78
    v_max_f32 v79, 0, v79
    v_pk_mul_f32 v[76:77], v[76:77], v[76:77]
    v_pk_mul_f32 v[78:79], v[78:79], v[78:79]
    v_cvt_pk_bf16_f32 v150, v76, v77
    v_cvt_pk_bf16_f32 v151, v78, v79
    v_pk_fma_f32 v[80:81], v[112:113], v[136:137], v[80:81] op_sel_hi:[1,0,1]
    v_pk_fma_f32 v[82:83], v[114:115], v[136:137], v[82:83] op_sel_hi:[1,0,1]
    v_permlane16_swap_b32 v148, v150
    v_permlane16_swap_b32 v149, v151
    buffer_store_dwordx4 v[148:151], v131, s[40:43], s60 offen offset:0 sc1
    v_pk_fma_f32 v[80:81], v[80:81], v[136:137], v[228:229] op_sel:[0,1,0]
    v_pk_fma_f32 v[82:83], v[82:83], v[136:137], v[230:231] op_sel:[0,1,0]
    v_max_f32 v80, 0, v80
    v_max_f32 v81, 0, v81
    v_max_f32 v82, 0, v82
    v_max_f32 v83, 0, v83
    v_pk_mul_f32 v[80:81], v[80:81], v[80:81]
    v_pk_mul_f32 v[82:83], v[82:83], v[82:83]
    v_cvt_pk_bf16_f32 v152, v80, v81
    v_cvt_pk_bf16_f32 v153, v82, v83
    v_pk_fma_f32 v[84:85], v[112:113], v[138:139], v[84:85] op_sel_hi:[1,0,1]
    v_pk_fma_f32 v[86:87], v[114:115], v[138:139], v[86:87] op_sel_hi:[1,0,1]
    v_pk_fma_f32 v[84:85], v[84:85], v[138:139], v[228:229] op_sel:[0,1,0]
    v_pk_fma_f32 v[86:87], v[86:87], v[138:139], v[230:231] op_sel:[0,1,0]
    v_max_f32 v84, 0, v84
    v_max_f32 v85, 0, v85
    v_max_f32 v86, 0, v86
    v_max_f32 v87, 0, v87
    v_pk_mul_f32 v[84:85], v[84:85], v[84:85]
    v_pk_mul_f32 v[86:87], v[86:87], v[86:87]
    v_cvt_pk_bf16_f32 v154, v84, v85
    v_cvt_pk_bf16_f32 v155, v86, v87
    v_pk_fma_f32 v[88:89], v[112:113], v[140:141], v[88:89] op_sel_hi:[1,0,1]
    v_pk_fma_f32 v[90:91], v[114:115], v[140:141], v[90:91] op_sel_hi:[1,0,1]
    v_permlane16_swap_b32 v152, v154
    v_permlane16_swap_b32 v153, v155
    buffer_store_dwordx4 v[152:155], v131, s[40:43], s60 offen offset:1536 sc1
    v_pk_fma_f32 v[88:89], v[88:89], v[140:141], v[228:229] op_sel:[0,1,0]
    v_pk_fma_f32 v[90:91], v[90:91], v[140:141], v[230:231] op_sel:[0,1,0]
    v_max_f32 v88, 0, v88
    v_max_f32 v89, 0, v89
    v_max_f32 v90, 0, v90
    v_max_f32 v91, 0, v91
    v_pk_mul_f32 v[88:89], v[88:89], v[88:89]
    v_pk_mul_f32 v[90:91], v[90:91], v[90:91]
    v_cvt_pk_bf16_f32 v156, v88, v89
    v_cvt_pk_bf16_f32 v157, v90, v91
    v_pk_fma_f32 v[92:93], v[112:113], v[142:143], v[92:93] op_sel_hi:[1,0,1]
    v_pk_fma_f32 v[94:95], v[114:115], v[142:143], v[94:95] op_sel_hi:[1,0,1]
    v_pk_fma_f32 v[92:93], v[92:93], v[142:143], v[228:229] op_sel:[0,1,0]
    v_pk_fma_f32 v[94:95], v[94:95], v[142:143], v[230:231] op_sel:[0,1,0]
    v_max_f32 v92, 0, v92
    v_max_f32 v93, 0, v93
    v_max_f32 v94, 0, v94
    v_max_f32 v95, 0, v95
    v_pk_mul_f32 v[92:93], v[92:93], v[92:93]
    v_pk_mul_f32 v[94:95], v[94:95], v[94:95]
    v_cvt_pk_bf16_f32 v158, v92, v93
    v_cvt_pk_bf16_f32 v159, v94, v95
    v_pk_fma_f32 v[96:97], v[112:113], v[144:145], v[96:97] op_sel_hi:[1,0,1]
    v_pk_fma_f32 v[98:99], v[114:115], v[144:145], v[98:99] op_sel_hi:[1,0,1]
    v_permlane16_swap_b32 v156, v158
    v_permlane16_swap_b32 v157, v159
    buffer_store_dwordx4 v[156:159], v131, s[40:43], s61 offen offset:0 sc1
    v_pk_fma_f32 v[96:97], v[96:97], v[144:145], v[228:229] op_sel:[0,1,0]
    v_pk_fma_f32 v[98:99], v[98:99], v[144:145], v[230:231] op_sel:[0,1,0]
    v_max_f32 v96, 0, v96
    v_max_f32 v97, 0, v97
    v_max_f32 v98, 0, v98
    v_max_f32 v99, 0, v99
    v_pk_mul_f32 v[96:97], v[96:97], v[96:97]
    v_pk_mul_f32 v[98:99], v[98:99], v[98:99]
    v_cvt_pk_bf16_f32 v160, v96, v97
    v_cvt_pk_bf16_f32 v161, v98, v99
    v_pk_fma_f32 v[100:101], v[112:113], v[146:147], v[100:101] op_sel_hi:[1,0,1]
    v_pk_fma_f32 v[102:103], v[114:115], v[146:147], v[102:103] op_sel_hi:[1,0,1]
    v_pk_fma_f32 v[100:101], v[100:101], v[146:147], v[228:229] op_sel:[0,1,0]
    v_pk_fma_f32 v[102:103], v[102:103], v[146:147], v[230:231] op_sel:[0,1,0]
    v_max_f32 v100, 0, v100
    v_max_f32 v101, 0, v101
    v_max_f32 v102, 0, v102
    v_max_f32 v103, 0, v103
    v_pk_mul_f32 v[100:101], v[100:101], v[100:101]
    v_pk_mul_f32 v[102:103], v[102:103], v[102:103]
    v_cvt_pk_bf16_f32 v162, v100, v101
    v_cvt_pk_bf16_f32 v163, v102, v103
    s_nop 0
    v_permlane16_swap_b32 v160, v162
    v_permlane16_swap_b32 v161, v163
    buffer_store_dwordx4 v[160:163], v131, s[40:43], s61 offen offset:1536 sc1
L_Hdone:
    s_barrier
    v_mov_b32 v116, s26
    v_mov_b32 v117, s27
    v_mov_b32 v118, s26
    v_mov_b32 v119, s27
    s_waitcnt vmcnt(0)
    buffer_store_dwordx4 v[116:119], v130, s[40:43], s72 offen sc1
    s_endpgm
.p2align 12
L_pg_25:
L_Aq:
    v_bfe_u32 v4, v1, 1, 1
    v_bfe_u32 v5, v1, 3, 1
    v_lshl_or_b32 v4, v5, 1, v4
    v_lshrrev_b32 v5, 2, v1
    v_xor_b32 v5, v5, v1
    v_and_or_b32 v4, v5, 4, v4
    v_and_b32 v5, 1, v1
    v_lshlrev_b32 v5, 4, v5
    v_mov_b32 v124, 0x3f80
    v_lshlrev_b32 v5, v5, v124
    v_cmp_eq_u32 vcc, 0, v4
    s_nop 1
    v_cndmask_b32 v120, 0, v5, vcc
    v_cmp_eq_u32 vcc, 1, v4
    s_nop 1
    v_cndmask_b32 v121, 0, v5, vcc
    v_cmp_eq_u32 vcc, 2, v4
    s_nop 1
    v_cndmask_b32 v122, 0, v5, vcc
    v_cmp_eq_u32 vcc, 3, v4
    s_nop 1
    v_cndmask_b32 v123, 0, v5, vcc
    v_lshlrev_b32 v5, 4, v3
    v_add_u32 v5, 132096, v5
    v_lshl_add_u32 v4, v2, 2, s56
    s_lshl_b32 s58, s75, 9
    s_add_u32 s58, s58, 11665408
    s_mov_b32 s3, 0
    s_mov_b32 s65, 0
    s_barrier
    ds_read_b64_tr_b16 v[228:229], v128 offset:16384
    ds_read_b64_tr_b16 v[230:231], v128 offset:16896
    ds_read_b64_tr_b16 v[232:233], v128 offset:20480
    ds_read_b64_tr_b16 v[234:235], v128 offset:20992
    ds_read_b64_tr_b16 v[236:237], v128 offset:24576
    ds_read_b64_tr_b16 v[238:239], v128 offset:25088
    ds_read_b64_tr_b16 v[240:241], v128 offset:28672
    ds_read_b64_tr_b16 v[242:243], v128 offset:29184
    ds_read_b64_tr_b16 v[244:245], v128 offset:32768
    ds_read_b64_tr_b16 v[246:247], v128 offset:33280
    ds_read_b64_tr_b16 v[248:249], v128 offset:36864
    ds_read_b64_tr_b16 v[250:251], v128 offset:37376
    ds_read_b128 v[132:135], v126 offset:0
    ds_read_b128 v[136:139], v127 offset:0
    ds_read_b128 v[140:143], v126 offset:2048
    ds_read_b128 v[144:147], v127 offset:2048
    ds_read_b128 v[148:151], v126 offset:4096
    ds_read_b128 v[152:155], v127 offset:4096
    ds_read_b128 v[156:159], v126 offset:6144
    ds_read_b128 v[160:163], v127 offset:6144
    s_waitcnt lgkmcnt(0)
.p2align 3
L_loopQ:
    v_mfma_f32_16x16x32_bf16 v[8:11], v[228:231], v[132:135], v[8:11]
    ds_read_b128 v[164:167], v126 offset:8192
    v_mfma_f32_16x16x32_bf16 v[8:11], v[232:235], v[136:139], v[8:11]
    ds_read_b128 v[168:171], v127 offset:8192
    v_mfma_f32_16x16x32_bf16 v[40:43], v[132:135], v[236:239], v[40:43]
    ds_read_b128 v[172:175], v126 offset:10240
    v_mfma_f32_16x16x32_bf16 v[40:43], v[136:139], v[240:243], v[40:43]
    ds_read_b128 v[176:179], v127 offset:10240
    v_mfma_f32_16x16x32_bf16 v[72:75], v[132:135], v[244:247], v[72:75]
    ds_read_b128 v[180:183], v126 offset:12288
    v_mfma_f32_16x16x32_bf16 v[72:75], v[136:139], v[248:251], v[72:75]
    ds_read_b128 v[184:187], v127 offset:12288
    v_mfma_f32_16x16x32_bf16 v[76:79], v[140:143], v[244:247], v[76:79]
    ds_read_b128 v[188:191], v126 offset:14336
    v_mfma_f32_16x16x32_bf16 v[76:79], v[144:147], v[248:251], v[76:79]
    ds_read_b128 v[192:195], v127 offset:14336
    v_mfma_f32_16x16x32_bf16 v[44:47], v[140:143], v[236:239], v[44:47]
    s_add_u32 s65, s65, 1
    s_cmp_eq_u32 s65, 3
    v_mfma_f32_16x16x32_bf16 v[44:47], v[144:147], v[240:243], v[44:47]
    s_cselect_b32 s64, 4294885376, s66
    v_mfma_f32_16x16x32_bf16 v[12:15], v[228:231], v[140:143], v[12:15]
    s_cselect_b32 s65, 0, s65
    s_add_u32 s3, s3, 1
    v_mfma_f32_16x16x32_bf16 v[12:15], v[232:235], v[144:147], v[12:15]
    v_add_u32 v126, s64, v126
    s_cmp_eq_u32 s3, 8
    v_mfma_f32_16x16x32_bf16 v[16:19], v[228:231], v[148:151], v[16:19]
    v_add_u32_e64 v127, s64, v127
    v_mfma_f32_16x16x32_bf16 v[16:19], v[232:235], v[152:155], v[16:19]
    v_add_u32_e64 v128, s64, v128
    v_mfma_f32_16x16x32_bf16 v[48:51], v[148:151], v[236:239], v[48:51]
    v_mfma_f32_16x16x32_bf16 v[48:51], v[152:155], v[240:243], v[48:51]
    v_mfma_f32_16x16x32_bf16 v[80:83], v[148:151], v[244:247], v[80:83]
    v_mfma_f32_16x16x32_bf16 v[80:83], v[152:155], v[248:251], v[80:83]
    v_mfma_f32_16x16x32_bf16 v[84:87], v[156:159], v[244:247], v[84:87]
    v_mfma_f32_16x16x32_bf16 v[84:87], v[160:163], v[248:251], v[84:87]
    v_mfma_f32_16x16x32_bf16 v[52:55], v[156:159], v[236:239], v[52:55]
    v_mfma_f32_16x16x32_bf16 v[52:55], v[160:163], v[240:243], v[52:55]
    v_mfma_f32_16x16x32_bf16 v[20:23], v[228:231], v[156:159], v[20:23]
    s_waitcnt lgkmcnt(0)
    s_nop 0
    v_mfma_f32_16x16x32_bf16 v[20:23], v[232:235], v[160:163], v[20:23]
    s_nop 0
    s_barrier
    v_mfma_f32_16x16x32_bf16 v[24:27], v[228:231], v[164:167], v[24:27]
    ds_read_b128 v[132:135], v126 offset:0
    v_mfma_f32_16x16x32_bf16 v[24:27], v[232:235], v[168:171], v[24:27]
    ds_read_b128 v[136:139], v127 offset:0
    v_mfma_f32_16x16x32_bf16 v[56:59], v[164:167], v[236:239], v[56:59]
    ds_read_b64_tr_b16 v[196:197], v128 offset:16384
    v_mfma_f32_16x16x32_bf16 v[56:59], v[168:171], v[240:243], v[56:59]
    ds_read_b64_tr_b16 v[198:199], v128 offset:16896
    v_mfma_f32_16x16x32_bf16 v[88:91], v[164:167], v[244:247], v[88:91]
    ds_read_b64_tr_b16 v[200:201], v128 offset:20480
    v_mfma_f32_16x16x32_bf16 v[88:91], v[168:171], v[248:251], v[88:91]
    ds_read_b64_tr_b16 v[202:203], v128 offset:20992
    v_mfma_f32_16x16x32_bf16 v[92:95], v[172:175], v[244:247], v[92:95]
    ds_read_b64_tr_b16 v[204:205], v128 offset:24576
    v_mfma_f32_16x16x32_bf16 v[92:95], v[176:179], v[248:251], v[92:95]
    ds_read_b64_tr_b16 v[206:207], v128 offset:25088
    v_mfma_f32_16x16x32_bf16 v[60:63], v[172:175], v[236:239], v[60:63]
    ds_read_b64_tr_b16 v[208:209], v128 offset:28672
    v_mfma_f32_16x16x32_bf16 v[60:63], v[176:179], v[240:243], v[60:63]
    ds_read_b64_tr_b16 v[210:211], v128 offset:29184
    v_mfma_f32_16x16x32_bf16 v[28:31], v[228:231], v[172:175], v[28:31]
    ds_read_b64_tr_b16 v[212:213], v128 offset:32768
    v_mfma_f32_16x16x32_bf16 v[28:31], v[232:235], v[176:179], v[28:31]
    ds_read_b64_tr_b16 v[214:215], v128 offset:33280
    v_mfma_f32_16x16x32_bf16 v[32:35], v[228:231], v[180:183], v[32:35]
    ds_read_b64_tr_b16 v[216:217], v128 offset:36864
    v_mfma_f32_16x16x32_bf16 v[32:35], v[232:235], v[184:187], v[32:35]
    ds_read_b64_tr_b16 v[218:219], v128 offset:37376
    v_mfma_f32_16x16x32_bf16 v[64:67], v[180:183], v[236:239], v[64:67]
    ds_read_b128 v[140:143], v126 offset:2048
    v_mfma_f32_16x16x32_bf16 v[64:67], v[184:187], v[240:243], v[64:67]
    ds_read_b128 v[144:147], v127 offset:2048
    v_mfma_f32_16x16x32_bf16 v[96:99], v[180:183], v[244:247], v[96:99]
    ds_read_b128 v[148:151], v126 offset:4096
    v_mfma_f32_16x16x32_bf16 v[96:99], v[184:187], v[248:251], v[96:99]
    ds_read_b128 v[152:155], v127 offset:4096
    v_mfma_f32_16x16x32_bf16 v[100:103], v[188:191], v[244:247], v[100:103]
    ds_read_b128 v[156:159], v126 offset:6144
    v_mfma_f32_16x16x32_bf16 v[100:103], v[192:195], v[248:251], v[100:103]
    ds_read_b128 v[160:163], v127 offset:6144
    v_mfma_f32_16x16x32_bf16 v[68:71], v[188:191], v[236:239], v[68:71]
    v_mfma_f32_16x16x32_bf16 v[68:71], v[192:195], v[240:243], v[68:71]
    v_mfma_f32_16x16x32_bf16 v[36:39], v[228:231], v[188:191], v[36:39]
    v_mfma_f32_16x16x32_bf16 v[36:39], v[232:235], v[192:195], v[36:39]
    s_waitcnt lgkmcnt(0)
    s_nop 0
    v_mfma_f32_16x16x32_bf16 v[8:11], v[196:199], v[132:135], v[8:11]
    ds_read_b128 v[164:167], v126 offset:8192
    v_mfma_f32_16x16x32_bf16 v[8:11], v[200:203], v[136:139], v[8:11]
    ds_read_b128 v[168:171], v127 offset:8192
    v_mfma_f32_16x16x32_bf16 v[40:43], v[132:135], v[204:207], v[40:43]
    ds_read_b128 v[172:175], v126 offset:10240
    v_mfma_f32_16x16x32_bf16 v[40:43], v[136:139], v[208:211], v[40:43]
    ds_read_b128 v[176:179], v127 offset:10240
    v_mfma_f32_16x16x32_bf16 v[72:75], v[132:135], v[212:215], v[72:75]
    ds_read_b128 v[180:183], v126 offset:12288
    v_mfma_f32_16x16x32_bf16 v[72:75], v[136:139], v[216:219], v[72:75]
    ds_read_b128 v[184:187], v127 offset:12288
    v_mfma_f32_16x16x32_bf16 v[76:79], v[140:143], v[212:215], v[76:79]
    ds_read_b128 v[188:191], v126 offset:14336
    v_mfma_f32_16x16x32_bf16 v[76:79], v[144:147], v[216:219], v[76:79]
    ds_read_b128 v[192:195], v127 offset:14336
    v_mfma_f32_16x16x32_bf16 v[44:47], v[140:143], v[204:207], v[44:47]
    s_add_u32 s65, s65, 1
    s_cmp_eq_u32 s65, 3
    v_mfma_f32_16x16x32_bf16 v[44:47], v[144:147], v[208:211], v[44:47]
    s_cselect_b32 s64, 4294885376, s66
    v_mfma_f32_16x16x32_bf16 v[12:15], v[196:199], v[140:143], v[12:15]
    s_cselect_b32 s65, 0, s65
    s_add_u32 s3, s3, 1
    v_mfma_f32_16x16x32_bf16 v[12:15], v[200:203], v[144:147], v[12:15]
    v_add_u32 v126, s64, v126
    s_cmp_eq_u32 s3, 8
    v_mfma_f32_16x16x32_bf16 v[16:19], v[196:199], v[148:151], v[16:19]
    v_add_u32_e64 v127, s64, v127
    v_mfma_f32_16x16x32_bf16 v[16:19], v[200:203], v[152:155], v[16:19]
    v_add_u32_e64 v128, s64, v128
    v_mfma_f32_16x16x32_bf16 v[48:51], v[148:151], v[204:207], v[48:51]
    v_mfma_f32_16x16x32_bf16 v[48:51], v[152:155], v[208:211], v[48:51]
    v_mfma_f32_16x16x32_bf16 v[80:83], v[148:151], v[212:215], v[80:83]
    v_mfma_f32_16x16x32_bf16 v[80:83], v[152:155], v[216:219], v[80:83]
    v_mfma_f32_16x16x32_bf16 v[84:87], v[156:159], v[212:215], v[84:87]
    v_mfma_f32_16x16x32_bf16 v[84:87], v[160:163], v[216:219], v[84:87]
    v_mfma_f32_16x16x32_bf16 v[52:55], v[156:159], v[204:207], v[52:55]
    v_mfma_f32_16x16x32_bf16 v[52:55], v[160:163], v[208:211], v[52:55]
    v_mfma_f32_16x16x32_bf16 v[20:23], v[196:199], v[156:159], v[20:23]
    s_waitcnt lgkmcnt(0)
    s_nop 0
    v_mfma_f32_16x16x32_bf16 v[20:23], v[200:203], v[160:163], v[20:23]
    s_cbranch_scc1 L_tailQ
    s_barrier
    v_mfma_f32_16x16x32_bf16 v[24:27], v[196:199], v[164:167], v[24:27]
    ds_read_b128 v[132:135], v126 offset:0
    v_mfma_f32_16x16x32_bf16 v[24:27], v[200:203], v[168:171], v[24:27]
    ds_read_b128 v[136:139], v127 offset:0
    v_mfma_f32_16x16x32_bf16 v[56:59], v[164:167], v[204:207], v[56:59]
    ds_read_b64_tr_b16 v[228:229], v128 offset:16384
    v_mfma_f32_16x16x32_bf16 v[56:59], v[168:171], v[208:211], v[56:59]
    ds_read_b64_tr_b16 v[230:231], v128 offset:16896
    v_mfma_f32_16x16x32_bf16 v[88:91], v[164:167], v[212:215], v[88:91]
    ds_read_b64_tr_b16 v[232:233], v128 offset:20480
    v_mfma_f32_16x16x32_bf16 v[88:91], v[168:171], v[216:219], v[88:91]
    ds_read_b64_tr_b16 v[234:235], v128 offset:20992
    v_mfma_f32_16x16x32_bf16 v[92:95], v[172:175], v[212:215], v[92:95]
    ds_read_b64_tr_b16 v[236:237], v128 offset:24576
    v_mfma_f32_16x16x32_bf16 v[92:95], v[176:179], v[216:219], v[92:95]
    ds_read_b64_tr_b16 v[238:239], v128 offset:25088
    v_mfma_f32_16x16x32_bf16 v[60:63], v[172:175], v[204:207], v[60:63]
    ds_read_b64_tr_b16 v[240:241], v128 offset:28672
    v_mfma_f32_16x16x32_bf16 v[60:63], v[176:179], v[208:211], v[60:63]
    ds_read_b64_tr_b16 v[242:243], v128 offset:29184
    v_mfma_f32_16x16x32_bf16 v[28:31], v[196:199], v[172:175], v[28:31]
    ds_read_b64_tr_b16 v[244:245], v128 offset:32768
    v_mfma_f32_16x16x32_bf16 v[28:31], v[200:203], v[176:179], v[28:31]
    ds_read_b64_tr_b16 v[246:247], v128 offset:33280
    v_mfma_f32_16x16x32_bf16 v[32:35], v[196:199], v[180:183], v[32:35]
    ds_read_b64_tr_b16 v[248:249], v128 offset:36864
    v_mfma_f32_16x16x32_bf16 v[32:35], v[200:203], v[184:187], v[32:35]
    ds_read_b64_tr_b16 v[250:251], v128 offset:37376
    v_mfma_f32_16x16x32_bf16 v[64:67], v[180:183], v[204:207], v[64:67]
    ds_read_b128 v[140:143], v126 offset:2048
    v_mfma_f32_16x16x32_bf16 v[64:67], v[184:187], v[208:211], v[64:67]
    ds_read_b128 v[144:147], v127 offset:2048
    v_mfma_f32_16x16x32_bf16 v[96:99], v[180:183], v[212:215], v[96:99]
    ds_read_b128 v[148:151], v126 offset:4096
    v_mfma_f32_16x16x32_bf16 v[96:99], v[184:187], v[216:219], v[96:99]
    ds_read_b128 v[152:155], v127 offset:4096
    v_mfma_f32_16x16x32_bf16 v[100:103], v[188:191], v[212:215], v[100:103]
    ds_read_b128 v[156:159], v126 offset:6144
    v_mfma_f32_16x16x32_bf16 v[100:103], v[192:195], v[216:219], v[100:103]
    ds_read_b128 v[160:163], v127 offset:6144
    v_mfma_f32_16x16x32_bf16 v[68:71], v[188:191], v[204:207], v[68:71]
    v_mfma_f32_16x16x32_bf16 v[68:71], v[192:195], v[208:211], v[68:71]
    v_mfma_f32_16x16x32_bf16 v[36:39], v[196:199], v[188:191], v[36:39]
    v_mfma_f32_16x16x32_bf16 v[36:39], v[200:203], v[192:195], v[36:39]
    s_waitcnt lgkmcnt(0)
    s_branch L_loopQ
.p2align 3
L_tailQ:
    s_setprio 2
    s_nop 0
    v_mfma_f32_16x16x32_bf16 v[56:59], v[164:167], v[204:207], v[56:59]
    ds_read_b128 v[104:107], v0
    v_mfma_f32_16x16x32_bf16 v[56:59], v[168:171], v[208:211], v[56:59]
    ds_read_b32 v112, v4 offset:512
    v_mfma_f32_16x16x32_bf16 v[60:63], v[172:175], v[204:207], v[60:63]
    ds_read_b32 v108, v4 offset:256
    v_mfma_f32_16x16x32_bf16 v[60:63], v[176:179], v[208:211], v[60:63]
    ds_read_b128 v[132:135], v5 offset:0
    v_mfma_f32_16x16x32_bf16 v[64:67], v[180:183], v[204:207], v[64:67]
    ds_read_b128 v[220:223], v5 offset:512
    v_mfma_f32_16x16x32_bf16 v[64:67], v[184:187], v[208:211], v[64:67]
    ds_read_b128 v[136:139], v5 offset:64
    v_mfma_f32_16x16x32_bf16 v[68:71], v[188:191], v[204:207], v[68:71]
    ds_read_b128 v[224:227], v5 offset:576
    v_mfma_f32_16x16x32_bf16 v[68:71], v[192:195], v[208:211], v[68:71]
    ds_read_b128 v[140:143], v5 offset:128
    v_mfma_f32_16x16x32_bf16 v[88:91], v[164:167], v[212:215], v[88:91]
    ds_read_b128 v[228:231], v5 offset:640
    v_mfma_f32_16x16x32_bf16 v[88:91], v[168:171], v[216:219], v[88:91]
    ds_read_b128 v[144:147], v5 offset:192
    v_mfma_f32_16x16x32_bf16 v[92:95], v[172:175], v[212:215], v[92:95]
    ds_read_b128 v[232:235], v5 offset:704
    v_mfma_f32_16x16x32_bf16 v[92:95], v[176:179], v[216:219], v[92:95]
    ds_read_b128 v[148:151], v5 offset:256
    v_mfma_f32_16x16x32_bf16 v[96:99], v[180:183], v[212:215], v[96:99]
    ds_read_b128 v[236:239], v5 offset:768
    v_mfma_f32_16x16x32_bf16 v[96:99], v[184:187], v[216:219], v[96:99]
    ds_read_b128 v[152:155], v5 offset:320
    v_mfma_f32_16x16x32_bf16 v[100:103], v[188:191], v[212:215], v[100:103]
    ds_read_b128 v[240:243], v5 offset:832
    v_mfma_f32_16x16x32_bf16 v[100:103], v[192:195], v[216:219], v[100:103]
    ds_read_b128 v[156:159], v5 offset:384
    v_mfma_f32_16x16x32_bf16 v[24:27], v[196:199], v[164:167], v[24:27]
    ds_read_b128 v[244:247], v5 offset:896
    v_mfma_f32_16x16x32_bf16 v[24:27], v[200:203], v[168:171], v[24:27]
    ds_read_b128 v[160:163], v5 offset:448
    v_mfma_f32_16x16x32_bf16 v[28:31], v[196:199], v[172:175], v[28:31]
    ds_read_b128 v[248:251], v5 offset:960
    v_mfma_f32_16x16x32_bf16 v[28:31], v[200:203], v[176:179], v[28:31]
    v_mfma_f32_16x16x32_bf16 v[32:35], v[196:199], v[180:183], v[32:35]
    v_mfma_f32_16x16x32_bf16 v[32:35], v[200:203], v[184:187], v[32:35]
    v_mfma_f32_16x16x32_bf16 v[36:39], v[196:199], v[188:191], v[36:39]
    v_mfma_f32_16x16x32_bf16 v[36:39], v[200:203], v[192:195], v[36:39]
    s_waitcnt lgkmcnt(0)
    v_min3_u32 v104, v104, v105, v106
    v_min_u32 v104, v104, v107
    v_cmp_ne_u32 vcc, 0, v104
    s_nop 0
    s_cmp_eq_u64 vcc, exec
    s_cbranch_scc0 L_nordyQ
L_rdyQ:
    ds_read_b128 v[104:107], v7
    ds_read_b64 v[196:197], v6 offset:0
    ds_read_b64 v[198:199], v6 offset:128
    ds_read_b64 v[200:201], v6 offset:256
    ds_read_b64 v[202:203], v6 offset:384
    ds_read_b64 v[204:205], v6 offset:512
    ds_read_b64 v[206:207], v6 offset:640
    ds_read_b64 v[110:111], v6 offset:768
    ds_read_b64 v[114:115], v6 offset:896
    v_pk_fma_f32 v[40:41], v[132:133], v[108:109], v[40:41] op_sel_hi:[1,0,1]
    v_pk_fma_f32 v[42:43], v[134:135], v[108:109], v[42:43] op_sel_hi:[1,0,1]
    v_pk_fma_f32 v[40:41], v[40:41], v[220:221], s[68:69]
    v_pk_fma_f32 v[42:43], v[42:43], v[222:223], s[68:69]
    v_pk_mul_f32 v[208:209], v[40:41], s[70:71]
    v_pk_mul_f32 v[210:211], v[42:43], s[70:71]
    v_exp_f32_e64 v208, v208 clamp
    v_exp_f32_e64 v209, v209 clamp
    v_exp_f32_e64 v210, v210 clamp
    v_exp_f32_e64 v211, v211 clamp
    v_max_f32 v40, s68, v40
    v_max_f32 v41, s68, v41
    v_max_f32 v42, s68, v42
    v_max_f32 v43, s68, v43
    v_pk_add_f32 v[40:41], v[40:41], v[208:209]
    v_pk_add_f32 v[42:43], v[42:43], v[210:211]
    v_cvt_pk_bf16_f32 v164, v40, v41
    v_cvt_pk_bf16_f32 v165, v42, v43
    v_pk_fma_f32 v[72:73], v[132:133], v[112:113], v[72:73] op_sel_hi:[1,0,1]
    v_pk_fma_f32 v[74:75], v[134:135], v[112:113], v[74:75] op_sel_hi:[1,0,1]
    v_pk_mul_f32 v[72:73], v[72:73], v[220:221]
    v_pk_mul_f32 v[74:75], v[74:75], v[222:223]
    v_cvt_pk_bf16_f32 v168, v72, v73
    v_cvt_pk_bf16_f32 v169, v74, v75
    v_pk_fma_f32 v[44:45], v[136:137], v[108:109], v[44:45] op_sel_hi:[1,0,1]
    v_pk_fma_f32 v[46:47], v[138:139], v[108:109], v[46:47] op_sel_hi:[1,0,1]
    v_pk_fma_f32 v[44:45], v[44:45], v[224:225], s[68:69]
    v_pk_fma_f32 v[46:47], v[46:47], v[226:227], s[68:69]
    v_pk_mul_f32 v[208:209], v[44:45], s[70:71]
    v_pk_mul_f32 v[210:211], v[46:47], s[70:71]
    v_exp_f32_e64 v208, v208 clamp
    v_exp_f32_e64 v209, v209 clamp
    v_exp_f32_e64 v210, v210 clamp
    v_exp_f32_e64 v211, v211 clamp
    v_max_f32 v44, s68, v44
    v_max_f32 v45, s68, v45
    v_max_f32 v46, s68, v46
    v_max_f32 v47, s68, v47
    v_pk_add_f32 v[44:45], v[44:45], v[208:209]
    v_pk_add_f32 v[46:47], v[46:47], v[210:211]
    v_cvt_pk_bf16_f32 v166, v44, v45
    v_cvt_pk_bf16_f32 v167, v46, v47
    v_pk_fma_f32 v[76:77], v[136:137], v[112:113], v[76:77] op_sel_hi:[1,0,1]
    v_pk_fma_f32 v[78:79], v[138:139], v[112:113], v[78:79] op_sel_hi:[1,0,1]
    v_pk_mul_f32 v[76:77], v[76:77], v[224:225]
    v_pk_mul_f32 v[78:79], v[78:79], v[226:227]
    v_cvt_pk_bf16_f32 v170, v76, v77
    v_cvt_pk_bf16_f32 v171, v78, v79
    v_pk_fma_f32 v[48:49], v[140:141], v[108:109], v[48:49] op_sel_hi:[1,0,1]
    v_pk_fma_f32 v[50:51], v[142:143], v[108:109], v[50:51] op_sel_hi:[1,0,1]
    v_mfma_f32_16x16x32_bf16 v[216:219], v[164:167], v[116:119], 0
    v_mfma_f32_16x16x32_bf16 v[212:215], v[164:167], v[168:171], 0
    v_pk_fma_f32 v[48:49], v[48:49], v[228:229], s[68:69]
    v_pk_fma_f32 v[50:51], v[50:51], v[230:231], s[68:69]
    v_pk_mul_f32 v[208:209], v[48:49], s[70:71]
    v_pk_mul_f32 v[210:211], v[50:51], s[70:71]
    v_exp_f32_e64 v208, v208 clamp
    v_exp_f32_e64 v209, v209 clamp
    v_exp_f32_e64 v210, v210 clamp
    v_exp_f32_e64 v211, v211 clamp
    v_max_f32 v48, s68, v48
    v_max_f32 v49, s68, v49
    v_max_f32 v50, s68, v50
    v_max_f32 v51, s68, v51
    v_pk_add_f32 v[48:49], v[48:49], v[208:209]
    v_pk_add_f32 v[50:51], v[50:51], v[210:211]
    v_cvt_pk_bf16_f32 v172, v48, v49
    v_cvt_pk_bf16_f32 v173, v50, v51
    v_pk_fma_f32 v[80:81], v[140:141], v[112:113], v[80:81] op_sel_hi:[1,0,1]
    v_pk_fma_f32 v[82:83], v[142:143], v[112:113], v[82:83] op_sel_hi:[1,0,1]
    v_pk_mul_f32 v[80:81], v[80:81], v[228:229]
    v_pk_mul_f32 v[82:83], v[82:83], v[230:231]
    v_cvt_pk_bf16_f32 v176, v80, v81
    v_cvt_pk_bf16_f32 v177, v82, v83
    v_pk_fma_f32 v[52:53], v[144:145], v[108:109], v[52:53] op_sel_hi:[1,0,1]
    v_pk_fma_f32 v[54:55], v[146:147], v[108:109], v[54:55] op_sel_hi:[1,0,1]
    v_pk_fma_f32 v[52:53], v[52:53], v[232:233], s[68:69]
    v_pk_fma_f32 v[54:55], v[54:55], v[234:235], s[68:69]
    v_pk_mul_f32 v[208:209], v[52:53], s[70:71]
    v_pk_mul_f32 v[210:211], v[54:55], s[70:71]
    v_exp_f32_e64 v208, v208 clamp
    v_exp_f32_e64 v209, v209 clamp
    v_exp_f32_e64 v210, v210 clamp
    v_exp_f32_e64 v211, v211 clamp
    v_max_f32 v52, s68, v52
    v_max_f32 v53, s68, v53
    v_max_f32 v54, s68, v54
    v_max_f32 v55, s68, v55
    v_pk_add_f32 v[52:53], v[52:53], v[208:209]
    v_pk_add_f32 v[54:55], v[54:55], v[210:211]
    v_cvt_pk_bf16_f32 v174, v52, v53
    v_cvt_pk_bf16_f32 v175, v54, v55
    v_pk_fma_f32 v[84:85], v[144:145], v[112:113], v[84:85] op_sel_hi:[1,0,1]
    v_pk_fma_f32 v[86:87], v[146:147], v[112:113], v[86:87] op_sel_hi:[1,0,1]
    v_pk_mul_f32 v[84:85], v[84:85], v[232:233]
    v_pk_mul_f32 v[86:87], v[86:87], v[234:235]
    v_cvt_pk_bf16_f32 v178, v84, v85
    v_cvt_pk_bf16_f32 v179, v86, v87
    v_pk_fma_f32 v[56:57], v[148:149], v[108:109], v[56:57] op_sel_hi:[1,0,1]
    v_pk_fma_f32 v[58:59], v[150:151], v[108:109], v[58:59] op_sel_hi:[1,0,1]
    v_mfma_f32_16x16x32_bf16 v[216:219], v[172:175], v[116:119], v[216:219]
    v_mfma_f32_16x16x32_bf16 v[212:215], v[172:175], v[176:179], v[212:215]
    v_pk_fma_f32 v[56:57], v[56:57], v[236:237], s[68:69]
    v_pk_fma_f32 v[58:59], v[58:59], v[238:239], s[68:69]
    v_pk_mul_f32 v[208:209], v[56:57], s[70:71]
    v_pk_mul_f32 v[210:211], v[58:59], s[70:71]
    v_exp_f32_e64 v208, v208 clamp
    v_exp_f32_e64 v209, v209 clamp
    v_exp_f32_e64 v210, v210 clamp
    v_exp_f32_e64 v211, v211 clamp
    v_max_f32 v56, s68, v56
    v_max_f32 v57, s68, v57
    v_max_f32 v58, s68, v58
    v_max_f32 v59, s68, v59
    v_pk_add_f32 v[56:57], v[56:57], v[208:209]
    v_pk_add_f32 v[58:59], v[58:59], v[210:211]
    v_cvt_pk_bf16_f32 v180, v56, v57
    v_cvt_pk_bf16_f32 v181, v58, v59
    v_pk_fma_f32 v[88:89], v[148:149], v[112:113], v[88:89] op_sel_hi:[1,0,1]
    v_pk_fma_f32 v[90:91], v[150:151], v[112:113], v[90:91] op_sel_hi:[1,0,1]
    v_pk_mul_f32 v[88:89], v[88:89], v[236:237]
    v_pk_mul_f32 v[90:91], v[90:91], v[238:239]
    v_cvt_pk_bf16_f32 v184, v88, v89
    v_cvt_pk_bf16_f32 v185, v90, v91
    v_pk_fma_f32 v[60:61], v[152:153], v[108:109], v[60:61] op_sel_hi:[1,0,1]
    v_pk_fma_f32 v[62:63], v[154:155], v[108:109], v[62:63] op_sel_hi:[1,0,1]
    v_pk_fma_f32 v[60:61], v[60:61], v[240:241], s[68:69]
    v_pk_fma_f32 v[62:63], v[62:63], v[242:243], s[68:69]
    v_pk_mul_f32 v[208:209], v[60:61], s[70:71]
    v_pk_mul_f32 v[210:211], v[62:63], s[70:71]
    v_exp_f32_e64 v208, v208 clamp
    v_exp_f32_e64 v209, v209 clamp
    v_exp_f32_e64 v210, v210 clamp
    v_exp_f32_e64 v211, v211 clamp
    v_max_f32 v60, s68, v60
    v_max_f32 v61, s68, v61
    v_max_f32 v62, s68, v62
    v_max_f32 v63, s68, v63
    v_pk_add_f32 v[60:61], v[60:61], v[208:209]
    v_pk_add_f32 v[62:63], v[62:63], v[210:211]
    v_cvt_pk_bf16_f32 v182, v60, v61
    v_cvt_pk_bf16_f32 v183, v62, v63
    v_pk_fma_f32 v[92:93], v[152:153], v[112:113], v[92:93] op_sel_hi:[1,0,1]
    v_pk_fma_f32 v[94:95], v[154:155], v[112:113], v[94:95] op_sel_hi:[1,0,1]
    v_pk_mul_f32 v[92:93], v[92:93], v[240:241]
    v_pk_mul_f32 v[94:95], v[94:95], v[242:243]
    v_cvt_pk_bf16_f32 v186, v92, v93
    v_cvt_pk_bf16_f32 v187, v94, v95
    v_pk_fma_f32 v[64:65], v[156:157], v[108:109], v[64:65] op_sel_hi:[1,0,1]
    v_pk_fma_f32 v[66:67], v[158:159], v[108:109], v[66:67] op_sel_hi:[1,0,1]
    v_mfma_f32_16x16x32_bf16 v[216:219], v[180:183], v[116:119], v[216:219]
    v_mfma_f32_16x16x32_bf16 v[212:215], v[180:183], v[184:187], v[212:215]
    v_pk_fma_f32 v[64:65], v[64:65], v[244:245], s[68:69]
    v_pk_fma_f32 v[66:67], v[66:67], v[246:247], s[68:69]
    v_pk_mul_f32 v[208:209], v[64:65], s[70:71]
    v_pk_mul_f32 v[210:211], v[66:67], s[70:71]
    v_exp_f32_e64 v208, v208 clamp
    v_exp_f32_e64 v209, v209 clamp
    v_exp_f32_e64 v210, v210 clamp
    v_exp_f32_e64 v211, v211 clamp
    v_max_f32 v64, s68, v64
    v_max_f32 v65, s68, v65
    v_max_f32 v66, s68, v66
    v_max_f32 v67, s68, v67
    v_pk_add_f32 v[64:65], v[64:65], v[208:209]
    v_pk_add_f32 v[66:67], v[66:67], v[210:211]
    v_cvt_pk_bf16_f32 v188, v64, v65
    v_cvt_pk_bf16_f32 v189, v66, v67
    v_pk_fma_f32 v[96:97], v[156:157], v[112:113], v[96:97] op_sel_hi:[1,0,1]
    v_pk_fma_f32 v[98:99], v[158:159], v[112:113], v[98:99] op_sel_hi:[1,0,1]
    v_pk_mul_f32 v[96:97], v[96:97], v[244:245]
    v_pk_mul_f32 v[98:99], v[98:99], v[246:247]
    v_cvt_pk_bf16_f32 v192, v96, v97
    v_cvt_pk_bf16_f32 v193, v98, v99
    v_pk_fma_f32 v[68:69], v[160:161], v[108:109], v[68:69] op_sel_hi:[1,0,1]
    v_pk_fma_f32 v[70:71], v[162:163], v[108:109], v[70:71] op_sel_hi:[1,0,1]
    v_pk_fma_f32 v[68:69], v[68:69], v[248:249], s[68:69]
    v_pk_fma_f32 v[70:71], v[70:71], v[250:251], s[68:69]
    v_pk_mul_f32 v[208:209], v[68:69], s[70:71]
    v_pk_mul_f32 v[210:211], v[70:71], s[70:71]
    v_exp_f32_e64 v208, v208 clamp
    v_exp_f32_e64 v209, v209 clamp
    v_exp_f32_e64 v210, v210 clamp
    v_exp_f32_e64 v211, v211 clamp
    v_max_f32 v68, s68, v68
    v_max_f32 v69, s68, v69
    v_max_f32 v70, s68, v70
    v_max_f32 v71, s68, v71
    v_pk_add_f32 v[68:69], v[68:69], v[208:209]
    v_pk_add_f32 v[70:71], v[70:71], v[210:211]
    v_cvt_pk_bf16_f32 v190, v68, v69
    v_cvt_pk_bf16_f32 v191, v70, v71
    v_pk_fma_f32 v[100:101], v[160:161], v[112:113], v[100:101] op_sel_hi:[1,0,1]
    v_pk_fma_f32 v[102:103], v[162:163], v[112:113], v[102:103] op_sel_hi:[1,0,1]
    v_pk_mul_f32 v[100:101], v[100:101], v[248:249]
    v_pk_mul_f32 v[102:103], v[102:103], v[250:251]
    v_cvt_pk_bf16_f32 v194, v100, v101
    v_cvt_pk_bf16_f32 v195, v102, v103
    v_cmp_gt_u32 vcc, 2, v2
    v_and_b32 v5, 1, v1
    v_lshl_add_u32 v5, v5, 2, v3
    v_lshrrev_b32 v4, 1, v2
    v_lshlrev_b32 v4, 17, v4
    v_lshl_add_u32 v4, v5, 4, v4
    v_mov_b32 v5, 1073741824
    v_mfma_f32_16x16x32_bf16 v[216:219], v[188:191], v[116:119], v[216:219]
    v_mfma_f32_16x16x32_bf16 v[212:215], v[188:191], v[192:195], v[212:215]
    v_cndmask_b32 v4, v5, v4, vcc
    v_cmp_gt_u32 vcc, 32, v1
    s_waitcnt lgkmcnt(0)
    s_nop 0
    v_cndmask_b32 v5, v5, v129, vcc
    v_pk_fma_f32 v[8:9], v[104:105], v[196:197], v[8:9] op_sel_hi:[1,0,1]
    v_pk_fma_f32 v[10:11], v[106:107], v[196:197], v[10:11] op_sel_hi:[1,0,1]
    v_pk_fma_f32 v[8:9], v[8:9], v[196:197], s[68:69] op_sel:[0,1,0]
    v_pk_fma_f32 v[10:11], v[10:11], v[196:197], s[68:69] op_sel:[0,1,0]
    v_cvt_pk_bf16_f32 v40, v212, v213
    v_cvt_pk_bf16_f32 v41, v214, v215
    v_cvt_pk_bf16_f32 v216, v216, v217
    v_cvt_pk_bf16_f32 v217, v218, v219
    v_permlane32_swap_b32 v40, v42
    v_permlane32_swap_b32 v41, v43
    buffer_store_dwordx4 v[40:43], v5, s[40:43], s58 offen sc1
    v_mov_b32 v218, s26
    v_mov_b32 v219, s27
    v_pk_mul_f32 v[208:209], v[8:9], s[70:71]
    v_pk_mul_f32 v[210:211], v[10:11], s[70:71]
    v_exp_f32_e64 v208, v208 clamp
    v_exp_f32_e64 v209, v209 clamp
    v_exp_f32_e64 v210, v210 clamp
    v_exp_f32_e64 v211, v211 clamp
    v_max_f32 v8, s68, v8
    v_max_f32 v9, s68, v9
    v_max_f32 v10, s68, v10
    v_max_f32 v11, s68, v11
    v_pk_add_f32 v[8:9], v[8:9], v[208:209]
    v_pk_add_f32 v[10:11], v[10:11], v[210:211]
    v_cvt_pk_bf16_f32 v164, v8, v9
    v_cvt_pk_bf16_f32 v165, v10, v11
    v_pk_fma_f32 v[12:13], v[104:105], v[198:199], v[12:13] op_sel_hi:[1,0,1]
    v_pk_fma_f32 v[14:15], v[106:107], v[198:199], v[14:15] op_sel_hi:[1,0,1]
    v_pk_fma_f32 v[12:13], v[12:13], v[198:199], s[68:69] op_sel:[0,1,0]
    v_pk_fma_f32 v[14:15], v[14:15], v[198:199], s[68:69] op_sel:[0,1,0]
    v_pk_mul_f32 v[208:209], v[12:13], s[70:71]
    v_pk_mul_f32 v[210:211], v[14:15], s[70:71]
    v_exp_f32_e64 v208, v208 clamp
    v_exp_f32_e64 v209, v209 clamp
    v_exp_f32_e64 v210, v210 clamp
    v_exp_f32_e64 v211, v211 clamp
    v_max_f32 v12, s68, v12
    v_max_f32 v13, s68, v13
    v_max_f32 v14, s68, v14
    v_max_f32 v15, s68, v15
    v_pk_add_f32 v[12:13], v[12:13], v[208:209]
    v_pk_add_f32 v[14:15], v[14:15], v[210:211]
    v_cvt_pk_bf16_f32 v166, v12, v13
    v_cvt_pk_bf16_f32 v167, v14, v15
    v_pk_fma_f32 v[16:17], v[104:105], v[200:201], v[16:17] op_sel_hi:[1,0,1]
    v_pk_fma_f32 v[18:19], v[106:107], v[200:201], v[18:19] op_sel_hi:[1,0,1]
    v_pk_fma_f32 v[16:17], v[16:17], v[200:201], s[68:69] op_sel:[0,1,0]
    v_pk_fma_f32 v[18:19], v[18:19], v[200:201], s[68:69] op_sel:[0,1,0]
    v_pk_mul_f32 v[208:209], v[16:17], s[70:71]
    v_pk_mul_f32 v[210:211], v[18:19], s[70:71]
    v_exp_f32_e64 v208, v208 clamp
    v_exp_f32_e64 v209, v209 clamp
    v_exp_f32_e64 v210, v210 clamp
    v_exp_f32_e64 v211, v211 clamp
    v_max_f32 v16, s68, v16
    v_max_f32 v17, s68, v17
    v_max_f32 v18, s68, v18
    v_max_f32 v19, s68, v19
    v_pk_add_f32 v[16:17], v[16:17], v[208:209]
    v_pk_add_f32 v[18:19], v[18:19], v[210:211]
    v_cvt_pk_bf16_f32 v168, v16, v17
    v_cvt_pk_bf16_f32 v169, v18, v19
    s_waitcnt vmcnt(0)
    buffer_store_dwordx4 v[216:219], v4, s[40:43], s73 offen sc1
    s_barrier
    v_pk_fma_f32 v[20:21], v[104:105], v[202:203], v[20:21] op_sel_hi:[1,0,1]
    v_pk_fma_f32 v[22:23], v[106:107], v[202:203], v[22:23] op_sel_hi:[1,0,1]
    v_pk_fma_f32 v[20:21], v[20:21], v[202:203], s[68:69] op_sel:[0,1,0]
    v_pk_fma_f32 v[22:23], v[22:23], v[202:203], s[68:69] op_sel:[0,1,0]
    v_pk_mul_f32 v[208:209], v[20:21], s[70:71]
    v_pk_mul_f32 v[210:211], v[22:23], s[70:71]
    v_exp_f32_e64 v208, v208 clamp
    v_exp_f32_e64 v209, v209 clamp
    v_exp_f32_e64 v210, v210 clamp
    v_exp_f32_e64 v211, v211 clamp
    v_max_f32 v20, s68, v20
    v_max_f32 v21, s68, v21
    v_max_f32 v22, s68, v22
    v_max_f32 v23, s68, v23
    v_pk_add_f32 v[20:21], v[20:21], v[208:209]
    v_pk_add_f32 v[22:23], v[22:23], v[210:211]
    v_cvt_pk_bf16_f32 v170, v20, v21
    v_cvt_pk_bf16_f32 v171, v22, v23
    v_pk_fma_f32 v[24:25], v[104:105], v[204:205], v[24:25] op_sel_hi:[1,0,1]
    v_pk_fma_f32 v[26:27], v[106:107], v[204:205], v[26:27] op_sel_hi:[1,0,1]
    v_pk_fma_f32 v[24:25], v[24:25], v[204:205], s[68:69] op_sel:[0,1,0]
    v_pk_fma_f32 v[26:27], v[26:27], v[204:205], s[68:69] op_sel:[0,1,0]
    v_pk_mul_f32 v[208:209], v[24:25], s[70:71]
    v_pk_mul_f32 v[210:211], v[26:27], s[70:71]
    v_exp_f32_e64 v208, v208 clamp
    v_exp_f32_e64 v209, v209 clamp
    v_exp_f32_e64 v210, v210 clamp
    v_exp_f32_e64 v211, v211 clamp
    v_max_f32 v24, s68, v24
    v_max_f32 v25, s68, v25
    v_max_f32 v26, s68, v26
    v_max_f32 v27, s68, v27
    v_pk_add_f32 v[24:25], v[24:25], v[208:209]
    v_pk_add_f32 v[26:27], v[26:27], v[210:211]
    v_cvt_pk_bf16_f32 v172, v24, v25
    v_cvt_pk_bf16_f32 v173, v26, v27
    v_pk_fma_f32 v[28:29], v[104:105], v[206:207], v[28:29] op_sel_hi:[1,0,1]
    v_pk_fma_f32 v[30:31], v[106:107], v[206:207], v[30:31] op_sel_hi:[1,0,1]
    v_pk_fma_f32 v[28:29], v[28:29], v[206:207], s[68:69] op_sel:[0,1,0]
    v_pk_fma_f32 v[30:31], v[30:31], v[206:207], s[68:69] op_sel:[0,1,0]
    v_pk_mul_f32 v[208:209], v[28:29], s[70:71]
    v_pk_mul_f32 v[210:211], v[30:31], s[70:71]
    v_exp_f32_e64 v208, v208 clamp
    v_exp_f32_e64 v209, v209 clamp
    v_exp_f32_e64 v210, v210 clamp
    v_exp_f32_e64 v211, v211 clamp
    v_max_f32 v28, s68, v28
    v_max_f32 v29, s68, v29
    v_max_f32 v30, s68, v30
    v_max_f32 v31, s68, v31
    v_pk_add_f32 v[28:29], v[28:29], v[208:209]
    v_pk_add_f32 v[30:31], v[30:31], v[210:211]
    v_cvt_pk_bf16_f32 v174, v28, v29
    v_cvt_pk_bf16_f32 v175, v30, v31
    v_pk_fma_f32 v[32:33], v[104:105], v[110:111], v[32:33] op_sel_hi:[1,0,1]
    v_pk_fma_f32 v[34:35], v[106:107], v[110:111], v[34:35] op_sel_hi:[1,0,1]
    v_pk_fma_f32 v[32:33], v[32:33], v[110:111], s[68:69] op_sel:[0,1,0]
    v_pk_fma_f32 v[34:35], v[34:35], v[110:111], s[68:69] op_sel:[0,1,0]
    v_pk_mul_f32 v[208:209], v[32:33], s[70:71]
    v_pk_mul_f32 v[210:211], v[34:35], s[70:71]
    v_exp_f32_e64 v208, v208 clamp
    v_exp_f32_e64 v209, v209 clamp
    v_exp_f32_e64 v210, v210 clamp
    v_exp_f32_e64 v211, v211 clamp
    v_max_f32 v32, s68, v32
    v_max_f32 v33, s68, v33
    v_max_f32 v34, s68, v34
    v_max_f32 v35, s68, v35
    v_pk_add_f32 v[32:33], v[32:33], v[208:209]
    v_pk_add_f32 v[34:35], v[34:35], v[210:211]
    v_cvt_pk_bf16_f32 v176, v32, v33
    v_cvt_pk_bf16_f32 v177, v34, v35
    v_pk_fma_f32 v[36:37], v[104:105], v[114:115], v[36:37] op_sel_hi:[1,0,1]
    v_pk_fma_f32 v[38:39], v[106:107], v[114:115], v[38:39] op_sel_hi:[1,0,1]
    v_pk_fma_f32 v[36:37], v[36:37], v[114:115], s[68:69] op_sel:[0,1,0]
    v_pk_fma_f32 v[38:39], v[38:39], v[114:115], s[68:69] op_sel:[0,1,0]
    v_pk_mul_f32 v[208:209], v[36:37], s[70:71]
    v_pk_mul_f32 v[210:211], v[38:39], s[70:71]
    v_exp_f32_e64 v208, v208 clamp
    v_exp_f32_e64 v209, v209 clamp
    v_exp_f32_e64 v210, v210 clamp
    v_exp_f32_e64 v211, v211 clamp
    v_max_f32 v36, s68, v36
    v_max_f32 v37, s68, v37
    v_max_f32 v38, s68, v38
    v_max_f32 v39, s68, v39
    v_pk_add_f32 v[36:37], v[36:37], v[208:209]
    v_pk_add_f32 v[38:39], v[38:39], v[210:211]
    v_cvt_pk_bf16_f32 v178, v36, v37
    v_cvt_pk_bf16_f32 v179, v38, v39
    s_lshl_b32 s60, s74, 12
    s_add_u32 s60, s60, 14319616
    s_lshl_b32 s57, s74, 13
    s_add_u32 s57, s57, 11665408
    s_add_u32 s61, s57, 4096
    v_lshlrev_b32 v4, 8, v2
    v_lshl_add_u32 v4, v3, 4, v4
    s_mov_b32 s3, 0
L_poll_26:
    s_sleep 10
    buffer_load_dwordx4 v[208:211], v4, s[40:43], s60 offen sc1
    s_add_u32 s3, s3, 1
    s_waitcnt vmcnt(0)
    v_cmp_eq_u64 vcc, s[26:27], v[210:211]
    s_cmp_lt_u32 s3, 262144
    s_cselect_b64 vcc, vcc, exec
    s_cmp_eq_u64 vcc, exec
    s_cbranch_scc0 L_poll_26
    buffer_load_dwordx4 v[72:75], v129, s[40:43], s57 offen offset:0 sc1
    buffer_load_dwordx4 v[76:79], v129, s[40:43], s57 offen offset:1024 sc1
    buffer_load_dwordx4 v[80:83], v129, s[40:43], s57 offen offset:2048 sc1
    buffer_load_dwordx4 v[84:87], v129, s[40:43], s57 offen offset:3072 sc1
    buffer_load_dwordx4 v[88:91], v129, s[40:43], s61 offen offset:0 sc1
    buffer_load_dwordx4 v[92:95], v129, s[40:43], s61 offen offset:1024 sc1
    buffer_load_dwordx4 v[96:99], v129, s[40:43], s61 offen offset:2048 sc1
    buffer_load_dwordx4 v[100:103], v129, s[40:43], s61 offen offset:3072 sc1
    s_mul_i32 s58, s48, 236
    s_add_u32 s58, s58, s74
    s_add_u32 s58, s58, 86
    s_mul_i32 s58, s58, 3072
    s_add_u32 s59, s58, 362496
    v_lshlrev_b32 v216, 16, v208
    v_and_b32 v217, 0xffff0000, v208
    v_lshlrev_b32 v218, 16, v209
    v_and_b32 v219, 0xffff0000, v209
    v_add_f32_dpp v216, v216, v216 row_ror:8 row_mask:0xf bank_mask:0xf
    v_add_f32_dpp v217, v217, v217 row_ror:8 row_mask:0xf bank_mask:0xf
    v_add_f32_dpp v218, v218, v218 row_ror:8 row_mask:0xf bank_mask:0xf
    v_add_f32_dpp v219, v219, v219 row_ror:8 row_mask:0xf bank_mask:0xf
    v_add_f32_dpp v216, v216, v216 row_ror:4 row_mask:0xf bank_mask:0xf
    v_add_f32_dpp v217, v217, v217 row_ror:4 row_mask:0xf bank_mask:0xf
    v_add_f32_dpp v218, v218, v218 row_ror:4 row_mask:0xf bank_mask:0xf
    v_add_f32_dpp v219, v219, v219 row_ror:4 row_mask:0xf bank_mask:0xf
    v_add_f32_dpp v216, v216, v216 row_ror:2 row_mask:0xf bank_mask:0xf
    v_add_f32_dpp v217, v217, v217 row_ror:2 row_mask:0xf bank_mask:0xf
    v_add_f32_dpp v218, v218, v218 row_ror:2 row_mask:0xf bank_mask:0xf
    v_add_f32_dpp v219, v219, v219 row_ror:2 row_mask:0xf bank_mask:0xf
    v_add_f32_dpp v216, v216, v216 row_ror:1 row_mask:0xf bank_mask:0xf
    v_add_f32_dpp v217, v217, v217 row_ror:1 row_mask:0xf bank_mask:0xf
    v_add_f32_dpp v218, v218, v218 row_ror:1 row_mask:0xf bank_mask:0xf
    v_add_f32_dpp v219, v219, v219 row_ror:1 row_mask:0xf bank_mask:0xf
    v_cvt_pk_bf16_f32 v208, v216, v217
    v_cvt_pk_bf16_f32 v209, v218, v219
    s_nop 1
    v_mfma_f32_16x16x16_bf16 v[220:223], v[208:209], v[164:165], 0
    v_mfma_f32_16x16x16_bf16 v[224:227], v[208:209], v[166:167], 0
    v_mfma_f32_16x16x16_bf16 v[228:231], v[208:209], v[168:169], 0
    v_mfma_f32_16x16x16_bf16 v[232:235], v[208:209], v[170:171], 0
    v_mfma_f32_16x16x16_bf16 v[236:239], v[208:209], v[172:173], 0
    v_mfma_f32_16x16x16_bf16 v[240:243], v[208:209], v[174:175], 0
    v_mfma_f32_16x16x16_bf16 v[244:247], v[208:209], v[176:177], 0
    v_mfma_f32_16x16x16_bf16 v[248:251], v[208:209], v[178:179], 0
    s_nop 0
    v_add_f32 v220, s68, v220
    v_add_f32 v224, s68, v224
    v_add_f32 v228, s68, v228
    v_add_f32 v232, s68, v232
    v_add_f32 v236, s68, v236
    v_add_f32 v240, s68, v240
    v_add_f32 v244, s68, v244
    v_add_f32 v248, s68, v248
    v_rcp_f32 v220, v220
    v_rcp_f32 v224, v224
    v_rcp_f32 v228, v228
    v_rcp_f32 v232, v232
    v_rcp_f32 v236, v236
    v_rcp_f32 v240, v240
    v_rcp_f32 v244, v244
    v_rcp_f32 v248, v248
    s_waitcnt vmcnt(7)
    v_mfma_f32_16x16x32_bf16 v[212:215], v[120:123], v[72:75], 0
    s_waitcnt vmcnt(6)
    v_mfma_f32_16x16x32_bf16 v[212:215], v[120:123], v[76:79], v[212:215]
    s_waitcnt vmcnt(5)
    v_mfma_f32_16x16x32_bf16 v[212:215], v[120:123], v[80:83], v[212:215]
    s_waitcnt vmcnt(4)
    v_mfma_f32_16x16x32_bf16 v[212:215], v[120:123], v[84:87], v[212:215]
    s_waitcnt vmcnt(3)
    v_mfma_f32_16x16x32_bf16 v[212:215], v[120:123], v[88:91], v[212:215]
    s_waitcnt vmcnt(2)
    v_mfma_f32_16x16x32_bf16 v[212:215], v[120:123], v[92:95], v[212:215]
    s_waitcnt vmcnt(1)
    v_mfma_f32_16x16x32_bf16 v[212:215], v[120:123], v[96:99], v[212:215]
    s_waitcnt vmcnt(0)
    v_mfma_f32_16x16x32_bf16 v[212:215], v[120:123], v[100:103], v[212:215]
    s_nop 7
    v_cvt_pk_bf16_f32 v210, v212, v213
    v_cvt_pk_bf16_f32 v211, v214, v215
    s_nop 1
    v_mfma_f32_16x16x16_bf16 v[8:11], v[210:211], v[164:165], 0
    v_mfma_f32_16x16x16_bf16 v[12:15], v[210:211], v[166:167], 0
    v_mfma_f32_16x16x16_bf16 v[16:19], v[210:211], v[168:169], 0
    v_mfma_f32_16x16x16_bf16 v[20:23], v[210:211], v[170:171], 0
    v_mfma_f32_16x16x16_bf16 v[24:27], v[210:211], v[172:173], 0
    v_mfma_f32_16x16x16_bf16 v[28:31], v[210:211], v[174:175], 0
    v_mfma_f32_16x16x16_bf16 v[32:35], v[210:211], v[176:177], 0
    v_mfma_f32_16x16x16_bf16 v[36:39], v[210:211], v[178:179], 0
    s_nop 0
    v_mul_f32 v8, v8, v220
    v_mul_f32 v9, v9, v220
    v_mul_f32 v10, v10, v220
    v_mul_f32 v11, v11, v220
    v_cvt_pk_bf16_f32 v132, v8, v9
    v_cvt_pk_bf16_f32 v133, v10, v11
    v_mul_f32 v12, v12, v224
    v_mul_f32 v13, v13, v224
    v_mul_f32 v14, v14, v224
    v_mul_f32 v15, v15, v224
    v_cvt_pk_bf16_f32 v134, v12, v13
    v_cvt_pk_bf16_f32 v135, v14, v15
    v_mul_f32 v16, v16, v228
    v_mul_f32 v17, v17, v228
    v_mul_f32 v18, v18, v228
    v_mul_f32 v19, v19, v228
    v_permlane16_swap_b32 v132, v134
    v_permlane16_swap_b32 v133, v135
    buffer_store_dwordx4 v[132:135], v131, s[40:43], s58 offen offset:0 sc1
    v_cvt_pk_bf16_f32 v136, v16, v17
    v_cvt_pk_bf16_f32 v137, v18, v19
    v_mul_f32 v20, v20, v232
    v_mul_f32 v21, v21, v232
    v_mul_f32 v22, v22, v232
    v_mul_f32 v23, v23, v232
    v_cvt_pk_bf16_f32 v138, v20, v21
    v_cvt_pk_bf16_f32 v139, v22, v23
    v_mul_f32 v24, v24, v236
    v_mul_f32 v25, v25, v236
    v_mul_f32 v26, v26, v236
    v_mul_f32 v27, v27, v236
    v_permlane16_swap_b32 v136, v138
    v_permlane16_swap_b32 v137, v139
    buffer_store_dwordx4 v[136:139], v131, s[40:43], s58 offen offset:1536 sc1
    v_cvt_pk_bf16_f32 v140, v24, v25
    v_cvt_pk_bf16_f32 v141, v26, v27
    v_mul_f32 v28, v28, v240
    v_mul_f32 v29, v29, v240
    v_mul_f32 v30, v30, v240
    v_mul_f32 v31, v31, v240
    v_cvt_pk_bf16_f32 v142, v28, v29
    v_cvt_pk_bf16_f32 v143, v30, v31
    v_mul_f32 v32, v32, v244
    v_mul_f32 v33, v33, v244
    v_mul_f32 v34, v34, v244
    v_mul_f32 v35, v35, v244
    v_permlane16_swap_b32 v140, v142
    v_permlane16_swap_b32 v141, v143
    buffer_store_dwordx4 v[140:143], v131, s[40:43], s59 offen offset:0 sc1
    v_cvt_pk_bf16_f32 v144, v32, v33
    v_cvt_pk_bf16_f32 v145, v34, v35
    v_mul_f32 v36, v36, v248
    v_mul_f32 v37, v37, v248
    v_mul_f32 v38, v38, v248
    v_mul_f32 v39, v39, v248
    v_cvt_pk_bf16_f32 v146, v36, v37
    v_cvt_pk_bf16_f32 v147, v38, v39
    s_nop 0
    v_permlane16_swap_b32 v144, v146
    v_permlane16_swap_b32 v145, v147
    buffer_store_dwordx4 v[144:147], v131, s[40:43], s59 offen offset:1536 sc1
    v_mov_b32 v116, s26
    v_mov_b32 v117, s27
    v_mov_b32 v118, s26
    v_mov_b32 v119, s27
    s_waitcnt vmcnt(0)
    buffer_store_dwordx4 v[116:119], v130, s[40:43], s72 offen sc1
    s_endpgm
L_B2:
    s_addk_i32 m0, 8192
    s_add_u32 s69, s69, s65
    buffer_load_dwordx4 v212, s[32:35], s69 offen  lds
    s_addk_i32 m0, 8192
    s_add_u32 s69, s69, s65
    buffer_load_dwordx4 v213, s[32:35], s69 offen  lds
    s_add_u32 m0, s74, 40960
    s_xor_b32 s61, s66, 4
    s_add_u32 s61, s61, s67
    s_and_b32 s61, s61, 7
    s_lshl_b32 s70, s61, 7
    s_mul_i32 s61, s61, s64
    s_add_u32 s68, s70, s78
    buffer_load_dwordx4 v208, s[28:31], s68 offen  lds
    s_addk_i32 m0, 1024
    s_nop 0
    buffer_load_dwordx4 v209, s[28:31], s68 offen  lds
    s_add_u32 m0, s76, 57344
    s_add_u32 s69, s61, s80
    buffer_load_dwordx4 v210, s[32:35], s69 offen  lds
    s_addk_i32 m0, 8192
    s_add_u32 s69, s69, s65
    buffer_load_dwordx4 v210, s[32:35], s69 offen  lds
    s_bitcmp1_b32 s48, 2
    s_cbranch_scc0 L_cs_5
    ds_read_b64_tr_b16 v[12:13], v221 offset:16384
    ds_read_b64_tr_b16 v[14:15], v221 offset:16896
    ds_read_b64_tr_b16 v[16:17], v221 offset:24576
    ds_read_b64_tr_b16 v[18:19], v221 offset:25088
    ds_read_b64_tr_b16 v[20:21], v221 offset:32768
    ds_read_b64_tr_b16 v[22:23], v221 offset:33280
    ds_read_b64_tr_b16 v[28:29], v221 offset:20480
    ds_read_b64_tr_b16 v[30:31], v221 offset:20992
    ds_read_b64_tr_b16 v[32:33], v221 offset:28672
    ds_read_b64_tr_b16 v[34:35], v221 offset:29184
    ds_read_b64_tr_b16 v[36:37], v221 offset:36864
    ds_read_b64_tr_b16 v[38:39], v221 offset:37376
L_cs_5:
    s_bitcmp1_b32 s48, 2
    s_cbranch_scc0 L_cs_6
    s_waitcnt lgkmcnt(0)
    v_mfma_f32_16x16x32_bf16 v[44:47], v[56:59], v[12:15], 0
    v_mfma_f32_16x16x32_bf16 v[48:51], v[56:59], v[16:19], 0
    v_mfma_f32_16x16x32_bf16 v[52:55], v[56:59], v[20:23], 0
    v_mfma_f32_16x16x32_bf16 v[44:47], v[56:59], v[28:31], v[44:47]
    v_mfma_f32_16x16x32_bf16 v[48:51], v[56:59], v[32:35], v[48:51]
    v_mfma_f32_16x16x32_bf16 v[52:55], v[56:59], v[36:39], v[52:55]
L_cs_6:
    s_addk_i32 m0, 8192
    s_add_u32 s69, s69, s65
    buffer_load_dwordx4 v211, s[32:35], s69 offen  lds
    s_add_u32 m0, s75, 40960
    s_add_u32 s68, s70, s79
    buffer_load_dwordx4 v208, s[28:31], s68 offen  lds
    s_waitcnt vmcnt(16)
    v_dot2c_f32_bf16 v206, v198, v56
    v_dot2c_f32_bf16 v207, v198, v198
    v_dot2c_f32_bf16 v206, v199, v56
    v_dot2c_f32_bf16 v207, v199, v199
    v_dot2c_f32_bf16 v206, v200, v56
    v_dot2c_f32_bf16 v207, v200, v200
    v_dot2c_f32_bf16 v206, v201, v56
    v_dot2c_f32_bf16 v207, v201, v201
    v_dot2c_f32_bf16 v206, v202, v56
    v_dot2c_f32_bf16 v207, v202, v202
    v_dot2c_f32_bf16 v206, v203, v56
    v_dot2c_f32_bf16 v207, v203, v203
    v_dot2c_f32_bf16 v206, v204, v56
    v_dot2c_f32_bf16 v207, v204, v204
    v_dot2c_f32_bf16 v206, v205, v56
    v_dot2c_f32_bf16 v207, v205, v205
    s_nop 1
    v_add_f32_dpp v206, v206, v206 quad_perm:[1,0,3,2] row_mask:0xf bank_mask:0xf
    v_add_f32_dpp v207, v207, v207 quad_perm:[1,0,3,2] row_mask:0xf bank_mask:0xf
    s_nop 0
    v_add_f32_dpp v206, v206, v206 quad_perm:[2,3,0,1] row_mask:0xf bank_mask:0xf
    v_add_f32_dpp v207, v207, v207 quad_perm:[2,3,0,1] row_mask:0xf bank_mask:0xf
    s_nop 0
    v_add_f32_dpp v206, v206, v206 row_half_mirror row_mask:0xf bank_mask:0xf
    v_add_f32_dpp v207, v207, v207 row_half_mirror row_mask:0xf bank_mask:0xf
    s_nop 0
    v_add_f32_dpp v206, v206, v206 row_mirror row_mask:0xf bank_mask:0xf
    v_add_f32_dpp v207, v207, v207 row_mirror row_mask:0xf bank_mask:0xf
    v_mov_b32 v72, v206
    v_mov_b32 v73, v207
    s_nop 0
    v_permlane16_swap_b32 v72, v206
    v_permlane16_swap_b32 v73, v207
    v_add_f32 v206, v206, v72
    v_add_f32 v207, v207, v73
    v_mul_f32 v206, 0x3b000000, v206
    v_mul_f32 v207, 0x3b000000, v207
    v_fma_f32 v207, -v206, v206, v207
    v_max_f32 v207, 0, v207
    v_cvt_pk_bf16_f32 v206, v207, v206
    v_lshlrev_b32 v207, 16, v206
    v_and_b32 v206, 0xffff0000, v206
    v_add_f32 v207, 0x3727c5ac, v207
    v_cvt_pk_bf16_f32 v207, v207, v207
    v_and_b32 v207, 0xffff0000, v207
    v_sqrt_f32 v207, v207
    v_xor_b32 v72, 0x80000000, v206
    v_cvt_pk_bf16_f32 v207, v207, v207
    v_and_b32 v207, 0xffff0000, v207
    v_rcp_f32 v73, v207
    s_nop 0
    buffer_store_dwordx4 v[72:75], v215, s[40:43], s54 offen sc1
    s_addk_i32 m0, 1024
    s_nop 0
    buffer_load_dwordx4 v209, s[28:31], s68 offen  lds
    s_waitcnt vmcnt(8)
    s_barrier
    s_add_u32 m0, s77, 57344
    s_add_u32 s69, s61, s81
    buffer_load_dwordx4 v212, s[32:35], s69 offen  lds
    s_addk_i32 m0, 8192
    s_add_u32 s69, s69, s65
    buffer_load_dwordx4 v212, s[32:35], s69 offen  lds
    s_addk_i32 m0, 8192
    s_add_u32 s69, s69, s65
    buffer_load_dwordx4 v213, s[32:35], s69 offen  lds
    s_bitcmp1_b32 s48, 2
    s_cbranch_scc0 L_cs_7
    ds_read_b64_tr_b16 v[12:13], v219 offset:16384
    ds_read_b64_tr_b16 v[14:15], v219 offset:16896
    ds_read_b64_tr_b16 v[16:17], v219 offset:24576
    ds_read_b64_tr_b16 v[18:19], v219 offset:25088
    ds_read_b64_tr_b16 v[20:21], v219 offset:32768
    ds_read_b64_tr_b16 v[22:23], v219 offset:33280
    ds_read_b64_tr_b16 v[28:29], v219 offset:20480
    ds_read_b64_tr_b16 v[30:31], v219 offset:20992
    ds_read_b64_tr_b16 v[32:33], v219 offset:28672
    ds_read_b64_tr_b16 v[34:35], v219 offset:29184
    ds_read_b64_tr_b16 v[36:37], v219 offset:36864
    ds_read_b64_tr_b16 v[38:39], v219 offset:37376
L_cs_7:
    s_add_u32 m0, s74, 81920
    s_xor_b32 s61, s66, 5
    s_add_u32 s61, s61, s67
    s_and_b32 s61, s61, 7
    s_lshl_b32 s70, s61, 7
    s_mul_i32 s61, s61, s64
    s_add_u32 s68, s70, s78
    buffer_load_dwordx4 v208, s[28:31], s68 offen  lds
    s_addk_i32 m0, 1024
    s_nop 0
    buffer_load_dwordx4 v209, s[28:31], s68 offen  lds
    s_add_u32 m0, s76, 98304
    s_add_u32 s69, s61, s80
    buffer_load_dwordx4 v210, s[32:35], s69 offen  lds
    s_bitcmp1_b32 s48, 2
    s_cbranch_scc0 L_cs_8
    s_waitcnt lgkmcnt(0)
    v_mfma_f32_16x16x32_bf16 v[44:47], v[56:59], v[12:15], v[44:47]
    v_mfma_f32_16x16x32_bf16 v[48:51], v[56:59], v[16:19], v[48:51]
    v_mfma_f32_16x16x32_bf16 v[52:55], v[56:59], v[20:23], v[52:55]
    v_mfma_f32_16x16x32_bf16 v[44:47], v[56:59], v[28:31], v[44:47]
    v_mfma_f32_16x16x32_bf16 v[48:51], v[56:59], v[32:35], v[48:51]
    v_mfma_f32_16x16x32_bf16 v[52:55], v[56:59], v[36:39], v[52:55]
L_cs_8:
    s_addk_i32 m0, 8192
    s_add_u32 s69, s69, s65
    buffer_load_dwordx4 v210, s[32:35], s69 offen  lds
    s_addk_i32 m0, 8192
    s_add_u32 s69, s69, s65
    buffer_load_dwordx4 v211, s[32:35], s69 offen  lds
    s_add_u32 m0, s75, 81920
    s_add_u32 s68, s70, s79
    buffer_load_dwordx4 v208, s[28:31], s68 offen  lds
    s_addk_i32 m0, 1024
    s_nop 0
    buffer_load_dwordx4 v209, s[28:31], s68 offen  lds
    s_add_u32 m0, s77, 98304
    s_add_u32 s69, s61, s81
    buffer_load_dwordx4 v212, s[32:35], s69 offen  lds
    s_addk_i32 m0, 8192
    s_add_u32 s69, s69, s65
    buffer_load_dwordx4 v212, s[32:35], s69 offen  lds
    s_addk_i32 m0, 8192
    s_add_u32 s69, s69, s65
    buffer_load_dwordx4 v213, s[32:35], s69 offen  lds
    s_waitcnt vmcnt(10)
    s_barrier
    v_mov_b32 v68, v44
    v_mov_b32 v69, v48
    v_mov_b32 v70, v52
    buffer_store_dwordx4 v[68:71], v216, s[40:43], s56 offen sc1
    s_add_u32 m0, s74, 0
    s_xor_b32 s61, s66, 6
    s_add_u32 s61, s61, s67
    s_and_b32 s61, s61, 7
    s_lshl_b32 s70, s61, 7
    s_mul_i32 s61, s61, s64
    s_add_u32 s68, s70, s78
    buffer_load_dwordx4 v208, s[28:31], s68 offen  lds
    s_addk_i32 m0, 1024
    s_nop 0
    buffer_load_dwordx4 v209, s[28:31], s68 offen  lds
    s_add_u32 m0, s76, 16384
    s_add_u32 s69, s61, s80
    buffer_load_dwordx4 v210, s[32:35], s69 offen  lds
    s_addk_i32 m0, 8192
    s_add_u32 s69, s69, s65
    buffer_load_dwordx4 v210, s[32:35], s69 offen  lds
    s_addk_i32 m0, 8192
    s_add_u32 s69, s69, s65
    buffer_load_dwordx4 v211, s[32:35], s69 offen  lds
    s_add_u32 m0, s75, 0
    s_add_u32 s68, s70, s79
    buffer_load_dwordx4 v208, s[28:31], s68 offen  lds
    s_addk_i32 m0, 1024
    s_nop 0
    buffer_load_dwordx4 v209, s[28:31], s68 offen  lds
    s_add_u32 m0, s77, 16384
    s_add_u32 s69, s61, s81
    buffer_load_dwordx4 v212, s[32:35], s69 offen  lds
    s_addk_i32 m0, 8192
    s_add_u32 s69, s69, s65
    buffer_load_dwordx4 v212, s[32:35], s69 offen  lds
    s_addk_i32 m0, 8192
    s_add_u32 s69, s69, s65
    buffer_load_dwordx4 v213, s[32:35], s69 offen  lds
    s_waitcnt vmcnt(11)
    s_barrier
    s_add_u32 m0, s74, 40960
    s_xor_b32 s61, s66, 7
    s_add_u32 s61, s61, s67
    s_and_b32 s61, s61, 7
    s_lshl_b32 s70, s61, 7
    s_mul_i32 s61, s61, s64
    s_add_u32 s68, s70, s78
    buffer_load_dwordx4 v208, s[28:31], s68 offen  lds
    s_addk_i32 m0, 1024
    s_nop 0
    buffer_load_dwordx4 v209, s[28:31], s68 offen  lds
    s_add_u32 m0, s76, 57344
    s_add_u32 s69, s61, s80
    buffer_load_dwordx4 v210, s[32:35], s69 offen  lds
    s_addk_i32 m0, 8192
    s_add_u32 s69, s69, s65
    buffer_load_dwordx4 v210, s[32:35], s69 offen  lds
    s_addk_i32 m0, 8192
    s_add_u32 s69, s69, s65
    buffer_load_dwordx4 v211, s[32:35], s69 offen  lds
    s_add_u32 m0, s75, 40960
    s_add_u32 s68, s70, s79
    buffer_load_dwordx4 v208, s[28:31], s68 offen  lds
    s_addk_i32 m0, 1024
    s_nop 0
    buffer_load_dwordx4 v209, s[28:31], s68 offen  lds
    s_add_u32 m0, s77, 57344
    s_add_u32 s69, s61, s81
    buffer_load_dwordx4 v212, s[32:35], s69 offen  lds
    s_addk_i32 m0, 8192
    s_add_u32 s69, s69, s65
    buffer_load_dwordx4 v212, s[32:35], s69 offen  lds
    s_addk_i32 m0, 8192
    s_add_u32 s69, s69, s65
    buffer_load_dwordx4 v213, s[32:35], s69 offen  lds
    s_waitcnt vmcnt(10)
    s_barrier
    buffer_load_dwordx4 v[60:63], v217, s[40:43], s57 offen sc1
    s_xor_b32 s12, s56, 4096
    buffer_load_dwordx4 v[12:15], v218, s[40:43], s12 offen sc1
    s_xor_b32 s12, s56, 8192
    buffer_load_dwordx4 v[16:19], v218, s[40:43], s12 offen sc1
    s_xor_b32 s12, s56, 12288
    buffer_load_dwordx4 v[20:23], v218, s[40:43], s12 offen sc1
    s_lshl2_add_u32 s12, s2, s45
    s_mul_i32 s58, s12, 1408
    s_lshl_b32 s12, s12, 9
    buffer_load_dword v255, v222, s[36:39], s58 offen
    s_mov_b64 s[36:37], s[8:9]
    s_mov_b32 s38, 524288
    buffer_load_dword v255, v223, s[36:39], s12 offen
    s_mov_b64 s[36:37], s[18:19]
    s_mov_b32 s38, 1024
    buffer_load_dwordx4 v[164:167], v236, s[36:39], s72 offen
    s_mov_b64 s[36:37], s[16:17]
    s_mov_b32 s38, 1409024
    s_lshl2_add_u32 s12, s46, s45
    s_mul_i32 s58, s12, 11264
    s_lshl_b32 s12, s12, 12
    buffer_load_dword v255, v224, s[36:39], s58 offen
    s_mov_b64 s[36:37], s[8:9]
    s_mov_b32 s38, 524288
    buffer_load_dword v255, v225, s[36:39], s12 offen
    s_mov_b64 s[36:37], s[16:17]
    s_mov_b32 s38, 1409024
    s_add_u32 m0, s71, 122880
    s_nop 0
    buffer_load_dwordx4 v3, s[36:39], s5 offen  lds
    s_addk_i32 m0, 1024
    s_addk_i32 s5, 8192
    buffer_load_dwordx4 v3, s[36:39], s5 offen  lds
    s_waitcnt vmcnt(11)
    s_barrier
    s_waitcnt vmcnt(7)
    v_xor_b32 v232, v15, v19
    v_xor_b32 v233, v23, v71
    v_xor_b32 v234, v15, v71
    v_or3_b32 v232, v232, v233, v234
    v_xor_b32 v63, v63, v232
    v_cmp_eq_u64 vcc, s[26:27], v[62:63]
    s_nop 0
    s_cmp_eq_u64 vcc, exec
    s_cbranch_scc0 L_pollslow_10
L_polldone_11:
    ds_write_b64 v226, v[60:61]
    ds_write2_b32 v227, v60, v61 offset1:128
    v_add_f32 v68, v68, v12
    v_add_f32 v69, v69, v13
    v_add_f32 v70, v70, v14
    v_add_f32 v68, v68, v16
    v_add_f32 v69, v69, v17
    v_add_f32 v70, v70, v18
    v_add_f32 v68, v68, v20
    v_add_f32 v69, v69, v21
    v_add_f32 v70, v70, v22
    ds_write2_b32 v228, v68, v69 offset1:64
    ds_write_b32 v228, v70 offset:512
    ds_write_b32 v229, v229
    buffer_load_dwordx4 v[168:171], v4, s[28:31], s13 offen
    buffer_load_dwordx4 v[176:179], v4, s[28:31], s59 offen
    s_mov_b32 s32, s20
    s_mov_b32 s33, s21
    s_mov_b32 s34, 2097152
    s_mov_b32 s35, 0x20000
    s_addk_i32 m0, 1024
    s_addk_i32 s5, 8192
    buffer_load_dwordx4 v3, s[36:39], s5 offen  lds
    s_addk_i32 m0, 1024
    s_addk_i32 s5, 8192
    buffer_load_dwordx4 v3, s[36:39], s5 offen  lds
    s_addk_i32 m0, 1024
    s_addk_i32 s5, 8192
    buffer_load_dwordx4 v3, s[36:39], s5 offen  lds
    s_addk_i32 m0, 1024
    s_addk_i32 s5, 8192
    buffer_load_dwordx4 v3, s[36:39], s5 offen  lds
    s_addk_i32 m0, 1024
    s_addk_i32 s5, 8192
    buffer_load_dwordx4 v3, s[36:39], s5 offen  lds
    s_addk_i32 m0, 1024
    s_addk_i32 s5, 8192
    buffer_load_dwordx4 v3, s[36:39], s5 offen  lds
    s_waitcnt vmcnt(8)
    ds_read_b64_tr_b16 v[76:77], v8 offset:40960
    ds_read_b64_tr_b16 v[78:79], v8 offset:41472
    ds_read_b64_tr_b16 v[80:81], v9 offset:40960
    ds_read_b64_tr_b16 v[82:83], v9 offset:41472
    s_add_u32 m0, s71, 81920
    s_addk_i32 s5, 8192
    buffer_load_dwordx4 v3, s[36:39], s5 offen  lds
    s_addk_i32 m0, 1024
    s_addk_i32 s5, 8192
    buffer_load_dwordx4 v3, s[36:39], s5 offen  lds
    s_waitcnt vmcnt(6)
    ds_read_b64_tr_b16 v[84:85], v8 offset:43008
    ds_read_b64_tr_b16 v[86:87], v8 offset:43520
    ds_read_b64_tr_b16 v[88:89], v9 offset:43008
    ds_read_b64_tr_b16 v[90:91], v9 offset:43520
    s_addk_i32 m0, 1024
    s_addk_i32 s5, 8192
    buffer_load_dwordx4 v3, s[36:39], s5 offen  lds
    s_addk_i32 m0, 1024
    s_addk_i32 s5, 8192
    buffer_load_dwordx4 v3, s[36:39], s5 offen  lds
    s_waitcnt vmcnt(6)
    ds_read_b64_tr_b16 v[92:93], v8 offset:45056
    ds_read_b64_tr_b16 v[94:95], v8 offset:45568
    ds_read_b64_tr_b16 v[96:97], v9 offset:45056
    ds_read_b64_tr_b16 v[98:99], v9 offset:45568
    s_addk_i32 m0, 1024
    s_addk_i32 s5, 8192
    buffer_load_dwordx4 v3, s[36:39], s5 offen  lds
    s_addk_i32 m0, 1024
    s_addk_i32 s5, 8192
    buffer_load_dwordx4 v3, s[36:39], s5 offen  lds
    s_waitcnt vmcnt(6)
    ds_read_b64_tr_b16 v[100:101], v8 offset:47104
    ds_read_b64_tr_b16 v[102:103], v8 offset:47616
    ds_read_b64_tr_b16 v[104:105], v9 offset:47104
    ds_read_b64_tr_b16 v[106:107], v9 offset:47616
    s_addk_i32 m0, 1024
    s_addk_i32 s5, 8192
    buffer_load_dwordx4 v3, s[36:39], s5 offen  lds
    s_addk_i32 m0, 1024
    s_addk_i32 s5, 8192
    buffer_load_dwordx4 v3, s[36:39], s5 offen  lds
    s_waitcnt vmcnt(6)
    ds_read_b64_tr_b16 v[108:109], v8 offset:0
    ds_read_b64_tr_b16 v[110:111], v8 offset:512
    ds_read_b64_tr_b16 v[112:113], v9 offset:0
    ds_read_b64_tr_b16 v[114:115], v9 offset:512
    s_addk_i32 m0, 1024
    s_addk_i32 s5, 8192
    buffer_load_dwordx4 v3, s[36:39], s5 offen  lds
    s_addk_i32 m0, 1024
    s_addk_i32 s5, 8192
    buffer_load_dwordx4 v3, s[36:39], s5 offen  lds
    s_waitcnt vmcnt(6)
    ds_read_b64_tr_b16 v[116:117], v8 offset:2048
    ds_read_b64_tr_b16 v[118:119], v8 offset:2560
    ds_read_b64_tr_b16 v[120:121], v9 offset:2048
    ds_read_b64_tr_b16 v[122:123], v9 offset:2560
    s_add_u32 m0, s71, 0
    s_addk_i32 s5, 8192
    buffer_load_dwordx4 v3, s[36:39], s5 offen  lds
    s_addk_i32 m0, 1024
    s_addk_i32 s5, 8192
    buffer_load_dwordx4 v3, s[36:39], s5 offen  lds
    s_waitcnt vmcnt(6)
    ds_read_b64_tr_b16 v[124:125], v8 offset:4096
    ds_read_b64_tr_b16 v[126:127], v8 offset:4608
    ds_read_b64_tr_b16 v[128:129], v9 offset:4096
    ds_read_b64_tr_b16 v[130:131], v9 offset:4608
    s_cmp_eq_u32 s50, 1
    s_cbranch_scc0 L_np_12
    s_barrier
L_np_12:
    s_addk_i32 m0, 1024
    s_addk_i32 s5, 8192
    buffer_load_dwordx4 v3, s[36:39], s5 offen  lds
    s_addk_i32 m0, 1024
    s_addk_i32 s5, 8192
    buffer_load_dwordx4 v3, s[36:39], s5 offen  lds
    s_waitcnt vmcnt(6)
    ds_read_b64_tr_b16 v[132:133], v8 offset:6144
    ds_read_b64_tr_b16 v[134:135], v8 offset:6656
    ds_read_b64_tr_b16 v[136:137], v9 offset:6144
    ds_read_b64_tr_b16 v[138:139], v9 offset:6656
    s_addk_i32 m0, 1024
    s_mov_b32 s5, s6
    buffer_load_dwordx4 v3, s[36:39], s5 offen  lds
    s_addk_i32 m0, 1024
    s_addk_i32 s5, 8192
    buffer_load_dwordx4 v3, s[36:39], s5 offen  lds
    s_waitcnt vmcnt(6)
    ds_read_b64_tr_b16 v[140:141], v8 offset:8192
    ds_read_b64_tr_b16 v[142:143], v8 offset:8704
    ds_read_b64_tr_b16 v[144:145], v9 offset:8192
    ds_read_b64_tr_b16 v[146:147], v9 offset:8704
    s_addk_i32 m0, 1024
    s_addk_i32 s5, 8192
    buffer_load_dwordx4 v3, s[36:39], s5 offen  lds
    s_addk_i32 m0, 1024
    s_addk_i32 s5, 8192
    buffer_load_dwordx4 v3, s[36:39], s5 offen  lds
    s_waitcnt vmcnt(6)
    ds_read_b64_tr_b16 v[148:149], v6 offset:0
    ds_read_b64_tr_b16 v[150:151], v6 offset:512
    ds_read_b64_tr_b16 v[152:153], v7 offset:0
    ds_read_b64_tr_b16 v[154:155], v7 offset:512
    s_addk_i32 m0, 1024
    s_addk_i32 s5, 8192
    buffer_load_dwordx4 v3, s[36:39], s5 offen  lds
    s_addk_i32 m0, 1024
    s_addk_i32 s5, 8192
    buffer_load_dwordx4 v3, s[36:39], s5 offen  lds
    s_waitcnt vmcnt(6)
    ds_read_b64_tr_b16 v[156:157], v6 offset:2048
    ds_read_b64_tr_b16 v[158:159], v6 offset:2560
    ds_read_b64_tr_b16 v[160:161], v7 offset:2048
    ds_read_b64_tr_b16 v[162:163], v7 offset:2560
    s_waitcnt lgkmcnt(0)
    s_add_u32 m0, s71, 122880
    s_addk_i32 s5, 8192
    buffer_load_dwordx4 v3, s[36:39], s5 offen  lds
    s_addk_i32 m0, 1024
    s_addk_i32 s5, 8192
    buffer_load_dwordx4 v3, s[36:39], s5 offen  lds
    s_cmp_eq_u32 s50, 0
    s_cbranch_scc0 L_np_13
    s_barrier
L_np_13:
    s_addk_i32 m0, 1024
    s_addk_i32 s5, 8192
    buffer_load_dwordx4 v3, s[36:39], s5 offen  lds
    s_addk_i32 m0, 1024
    s_addk_i32 s5, 8192
    buffer_load_dwordx4 v3, s[36:39], s5 offen  lds
    s_addk_i32 m0, 1024
    s_addk_i32 s5, 8192
    buffer_load_dwordx4 v3, s[36:39], s5 offen  lds
    s_addk_i32 m0, 1024
    s_addk_i32 s5, 8192
    buffer_load_dwordx4 v3, s[36:39], s5 offen  lds
    s_addk_i32 m0, 1024
    s_addk_i32 s5, 8192
    buffer_load_dwordx4 v3, s[36:39], s5 offen  lds
    s_addk_i32 m0, 1024
    s_addk_i32 s5, 8192
    buffer_load_dwordx4 v3, s[36:39], s5 offen  lds
    s_add_u32 m0, s71, 81920
    s_addk_i32 s5, 8192
    buffer_load_dwordx4 v3, s[36:39], s5 offen  lds
    s_addk_i32 m0, 1024
    s_addk_i32 s5, 8192
    buffer_load_dwordx4 v3, s[36:39], s5 offen  lds
    s_addk_i32 m0, 1024
    s_addk_i32 s5, 8192
    buffer_load_dwordx4 v3, s[36:39], s5 offen  lds
    s_addk_i32 m0, 1024
    s_addk_i32 s5, 8192
    buffer_load_dwordx4 v3, s[36:39], s5 offen  lds
    s_addk_i32 m0, 1024
    s_addk_i32 s5, 8192
    buffer_load_dwordx4 v3, s[36:39], s5 offen  lds
    s_addk_i32 m0, 1024
    s_addk_i32 s5, 8192
    buffer_load_dwordx4 v3, s[36:39], s5 offen  lds
    s_addk_i32 m0, 1024
    s_addk_i32 s5, 8192
    buffer_load_dwordx4 v3, s[36:39], s5 offen  lds
    s_addk_i32 m0, 1024
    s_addk_i32 s5, 8192
    buffer_load_dwordx4 v3, s[36:39], s5 offen  lds
    s_addk_i32 m0, 1024
    s_mov_b64 s[36:37], s[8:9]
    s_mov_b32 s38, 524288
    s_lshl1_add_u32 s5, s45, s15
    s_lshl_b32 s5, s5, 16
    s_add_u32 s5, s5, s72
    s_xor_b32 s6, s5, 0x10000
    buffer_load_dwordx4 v3, s[36:39], s5 offen  lds
    s_addk_i32 m0, 1024
    s_addk_i32 s5, 8192
    buffer_load_dwordx4 v3, s[36:39], s5 offen  lds
    s_add_u32 m0, s71, 0
    s_addk_i32 s5, 8192
    buffer_load_dwordx4 v3, s[36:39], s5 offen  lds
    s_addk_i32 m0, 1024
    s_addk_i32 s5, 8192
    buffer_load_dwordx4 v3, s[36:39], s5 offen  lds
    s_addk_i32 m0, 1024
    s_addk_i32 s5, 8192
    buffer_load_dwordx4 v3, s[36:39], s5 offen  lds
    s_addk_i32 m0, 1024
    s_addk_i32 s5, 8192
    buffer_load_dwordx4 v3, s[36:39], s5 offen  lds
    s_add_u32 m0, s71, 40960
    s_addk_i32 s5, 8192
    buffer_load_dwordx4 v3, s[36:39], s5 offen  lds
    s_addk_i32 m0, 1024
    s_addk_i32 s5, 8192
    buffer_load_dwordx4 v3, s[36:39], s5 offen  lds
    s_addk_i32 m0, 1024
    s_mov_b32 s5, s6
    buffer_load_dwordx4 v3, s[36:39], s5 offen  lds
    s_addk_i32 m0, 1024
    s_addk_i32 s5, 8192
    buffer_load_dwordx4 v3, s[36:39], s5 offen  lds
    s_addk_i32 m0, 1024
    s_addk_i32 s5, 8192
    buffer_load_dwordx4 v3, s[36:39], s5 offen  lds
    s_addk_i32 m0, 1024
    s_addk_i32 s5, 8192
    buffer_load_dwordx4 v3, s[36:39], s5 offen  lds
    buffer_load_dwordx2 v[10:11], v5, s[40:43], s60 offen sc1
    s_addk_i32 m0, 1024
    s_addk_i32 s5, 8192
    buffer_load_dwordx4 v3, s[36:39], s5 offen  lds
    s_addk_i32 m0, 1024
    s_addk_i32 s5, 8192
    buffer_load_dwordx4 v3, s[36:39], s5 offen  lds
    s_addk_i32 m0, 1024
    s_addk_i32 s5, 8192
    buffer_load_dwordx4 v3, s[36:39], s5 offen  lds
    s_addk_i32 m0, 1024
    s_addk_i32 s5, 8192
    buffer_load_dwordx4 v3, s[36:39], s5 offen  lds
    s_branch L_pg_14
.p2align 12
L_pg_14:
    s_waitcnt vmcnt(4)
    v_cmp_eq_u64 vcc, s[26:27], v[10:11]
    s_nop 0
    s_cmp_eq_u64 vcc, exec
    s_cbranch_scc0 L_pollslow_16
L_polldone_17:
    s_add_u32 s12, s7, 0
    buffer_load_dwordx4 v[198:201], v2, s[40:43], s12 offen offset:0 sc1
    buffer_load_dwordx4 v[202:205], v2, s[40:43], s12 offen offset:1536 sc1
    s_add_u32 s12, s7, 3072
    buffer_load_dwordx4 v[206:209], v2, s[40:43], s12 offen offset:0 sc1
    buffer_load_dwordx4 v[210:213], v2, s[40:43], s12 offen offset:1536 sc1
    s_add_u32 s12, s7, 6144
    buffer_load_dwordx4 v[214:217], v2, s[40:43], s12 offen offset:0 sc1
    buffer_load_dwordx4 v[218:221], v2, s[40:43], s12 offen offset:1536 sc1
    s_add_u32 s12, s7, 9216
    buffer_load_dwordx4 v[222:225], v2, s[40:43], s12 offen offset:0 sc1
    buffer_load_dwordx4 v[226:229], v2, s[40:43], s12 offen offset:1536 sc1
    s_mov_b32 m0, s71
    s_waitcnt vmcnt(6)
    v_mfma_f32_32x32x16_bf16 v[12:27], v[198:201], v[76:79], 0
    s_add_u32 s12, s7, 12288
    v_mfma_f32_32x32x16_bf16 v[28:43], v[198:201], v[80:83], 0
    buffer_load_dwordx4 v[230:233], v2, s[40:43], s12 offen offset:0 sc1
    v_mfma_f32_32x32x16_bf16 v[44:59], v[202:205], v[76:79], 0
    buffer_load_dwordx4 v[234:237], v2, s[40:43], s12 offen offset:1536 sc1
    v_mfma_f32_32x32x16_bf16 v[60:75], v[202:205], v[80:83], 0
    s_waitcnt vmcnt(6)
    v_mfma_f32_32x32x16_bf16 v[12:27], v[206:209], v[84:87], v[12:27]
    s_add_u32 s12, s7, 15360
    v_mfma_f32_32x32x16_bf16 v[28:43], v[206:209], v[88:91], v[28:43]
    buffer_load_dwordx4 v[198:201], v2, s[40:43], s12 offen offset:0 sc1
    v_mfma_f32_32x32x16_bf16 v[44:59], v[210:213], v[84:87], v[44:59]
    buffer_load_dwordx4 v[202:205], v2, s[40:43], s12 offen offset:1536 sc1
    v_mfma_f32_32x32x16_bf16 v[60:75], v[210:213], v[88:91], v[60:75]
    s_waitcnt vmcnt(6)
    v_mfma_f32_32x32x16_bf16 v[12:27], v[214:217], v[92:95], v[12:27]
    ds_read_b64_tr_b16 v[76:77], v8 offset:8192
    ds_read_b64_tr_b16 v[78:79], v8 offset:8704
    s_add_u32 s12, s7, 18432
    v_mfma_f32_32x32x16_bf16 v[28:43], v[214:217], v[96:99], v[28:43]
    ds_read_b64_tr_b16 v[80:81], v9 offset:8192
    ds_read_b64_tr_b16 v[82:83], v9 offset:8704
    buffer_load_dwordx4 v[206:209], v2, s[40:43], s12 offen offset:0 sc1
    v_mfma_f32_32x32x16_bf16 v[44:59], v[218:221], v[92:95], v[44:59]
    buffer_load_dwordx4 v[210:213], v2, s[40:43], s12 offen offset:1536 sc1
    v_mfma_f32_32x32x16_bf16 v[60:75], v[218:221], v[96:99], v[60:75]
    s_waitcnt vmcnt(6)
    v_mfma_f32_32x32x16_bf16 v[12:27], v[222:225], v[100:103], v[12:27]
    ds_read_b64_tr_b16 v[84:85], v6 offset:0
    ds_read_b64_tr_b16 v[86:87], v6 offset:512
    s_add_u32 s12, s7, 21504
    v_mfma_f32_32x32x16_bf16 v[28:43], v[222:225], v[104:107], v[28:43]
    ds_read_b64_tr_b16 v[88:89], v7 offset:0
    ds_read_b64_tr_b16 v[90:91], v7 offset:512
    buffer_load_dwordx4 v[214:217], v2, s[40:43], s12 offen offset:0 sc1
    v_mfma_f32_32x32x16_bf16 v[44:59], v[226:229], v[100:103], v[44:59]
    buffer_load_dwordx4 v[218:221], v2, s[40:43], s12 offen offset:1536 sc1
    v_mfma_f32_32x32x16_bf16 v[60:75], v[226:229], v[104:107], v[60:75]
    s_waitcnt vmcnt(6)
    v_mfma_f32_32x32x16_bf16 v[12:27], v[230:233], v[108:111], v[12:27]
    ds_read_b64_tr_b16 v[92:93], v6 offset:2048
    ds_read_b64_tr_b16 v[94:95], v6 offset:2560
    s_add_u32 s12, s7, 24576
    v_mfma_f32_32x32x16_bf16 v[28:43], v[230:233], v[112:115], v[28:43]
    ds_read_b64_tr_b16 v[96:97], v7 offset:2048
    ds_read_b64_tr_b16 v[98:99], v7 offset:2560
    buffer_load_dwordx4 v[222:225], v2, s[40:43], s12 offen offset:0 sc1
    v_mfma_f32_32x32x16_bf16 v[44:59], v[234:237], v[108:111], v[44:59]
    buffer_load_dwordx4 v[226:229], v2, s[40:43], s12 offen offset:1536 sc1
    v_mfma_f32_32x32x16_bf16 v[60:75], v[234:237], v[112:115], v[60:75]
    s_waitcnt vmcnt(6)
    v_mfma_f32_32x32x16_bf16 v[12:27], v[198:201], v[116:119], v[12:27]
    ds_read_b64_tr_b16 v[100:101], v6 offset:40960
    ds_read_b64_tr_b16 v[102:103], v6 offset:41472
    s_add_u32 s12, s7, 27648
    s_cmp_ge_u32 s12, s11
    s_cselect_b32 s12, 1073741824, s12
    v_mfma_f32_32x32x16_bf16 v[28:43], v[198:201], v[120:123], v[28:43]
    ds_read_b64_tr_b16 v[104:105], v7 offset:40960
    ds_read_b64_tr_b16 v[106:107], v7 offset:41472
    buffer_load_dwordx4 v[230:233], v2, s[40:43], s12 offen offset:0 sc1
    v_mfma_f32_32x32x16_bf16 v[44:59], v[202:205], v[116:119], v[44:59]
    buffer_load_dwordx4 v[234:237], v2, s[40:43], s12 offen offset:1536 sc1
    v_mfma_f32_32x32x16_bf16 v[60:75], v[202:205], v[120:123], v[60:75]
    s_waitcnt vmcnt(6)
    v_mfma_f32_32x32x16_bf16 v[12:27], v[206:209], v[124:127], v[12:27]
    ds_read_b64_tr_b16 v[108:109], v6 offset:43008
    ds_read_b64_tr_b16 v[110:111], v6 offset:43520
    s_add_u32 s12, s7, 30720
    s_cmp_ge_u32 s12, s11
    s_cselect_b32 s12, 1073741824, s12
    v_mfma_f32_32x32x16_bf16 v[28:43], v[206:209], v[128:131], v[28:43]
    ds_read_b64_tr_b16 v[112:113], v7 offset:43008
    ds_read_b64_tr_b16 v[114:115], v7 offset:43520
    buffer_load_dwordx4 v[198:201], v2, s[40:43], s12 offen offset:0 sc1
    v_mfma_f32_32x32x16_bf16 v[44:59], v[210:213], v[124:127], v[44:59]
    buffer_load_dwordx4 v[202:205], v2, s[40:43], s12 offen offset:1536 sc1
    v_mfma_f32_32x32x16_bf16 v[60:75], v[210:213], v[128:131], v[60:75]
    s_waitcnt vmcnt(6)
    v_mfma_f32_32x32x16_bf16 v[12:27], v[214:217], v[132:135], v[12:27]
    ds_read_b64_tr_b16 v[116:117], v6 offset:45056
    ds_read_b64_tr_b16 v[118:119], v6 offset:45568
    s_add_u32 s12, s10, 0
    v_mfma_f32_32x32x16_bf16 v[28:43], v[214:217], v[136:139], v[28:43]
    ds_read_b64_tr_b16 v[120:121], v7 offset:45056
    ds_read_b64_tr_b16 v[122:123], v7 offset:45568
    buffer_load_dwordx4 v[206:209], v2, s[40:43], s12 offen offset:0 sc1
    v_mfma_f32_32x32x16_bf16 v[44:59], v[218:221], v[132:135], v[44:59]
    buffer_load_dwordx4 v[210:213], v2, s[40:43], s12 offen offset:1536 sc1
    v_mfma_f32_32x32x16_bf16 v[60:75], v[218:221], v[136:139], v[60:75]
    s_waitcnt vmcnt(6)
    v_mfma_f32_32x32x16_bf16 v[12:27], v[222:225], v[140:143], v[12:27]
    ds_read_b64_tr_b16 v[124:125], v6 offset:47104
    ds_read_b64_tr_b16 v[126:127], v6 offset:47616
    s_add_u32 s12, s10, 3072
    v_mfma_f32_32x32x16_bf16 v[28:43], v[222:225], v[144:147], v[28:43]
    ds_read_b64_tr_b16 v[128:129], v7 offset:47104
    ds_read_b64_tr_b16 v[130:131], v7 offset:47616
    buffer_load_dwordx4 v[214:217], v2, s[40:43], s12 offen offset:0 sc1
    v_mfma_f32_32x32x16_bf16 v[44:59], v[226:229], v[140:143], v[44:59]
    buffer_load_dwordx4 v[218:221], v2, s[40:43], s12 offen offset:1536 sc1
    v_mfma_f32_32x32x16_bf16 v[60:75], v[226:229], v[144:147], v[60:75]
    s_waitcnt vmcnt(6)
    v_mfma_f32_32x32x16_bf16 v[12:27], v[230:233], v[148:151], v[12:27]
    ds_read_b64_tr_b16 v[132:133], v6 offset:49152
    ds_read_b64_tr_b16 v[134:135], v6 offset:49664
    s_add_u32 s12, s10, 6144
    v_mfma_f32_32x32x16_bf16 v[28:43], v[230:233], v[152:155], v[28:43]
    ds_read_b64_tr_b16 v[136:137], v7 offset:49152
    ds_read_b64_tr_b16 v[138:139], v7 offset:49664
    buffer_load_dwordx4 v[222:225], v2, s[40:43], s12 offen offset:0 sc1
    v_mfma_f32_32x32x16_bf16 v[44:59], v[234:237], v[148:151], v[44:59]
    buffer_load_dwordx4 v[226:229], v2, s[40:43], s12 offen offset:1536 sc1
    v_mfma_f32_32x32x16_bf16 v[60:75], v[234:237], v[152:155], v[60:75]
    s_waitcnt vmcnt(6)
    v_mfma_f32_32x32x16_bf16 v[12:27], v[198:201], v[156:159], v[12:27]
    ds_read_b64_tr_b16 v[190:191], v6 offset:4096
    ds_read_b64_tr_b16 v[192:193], v6 offset:4608
    s_add_u32 s12, s10, 9216
    v_mfma_f32_32x32x16_bf16 v[28:43], v[198:201], v[160:163], v[28:43]
    ds_read_b64_tr_b16 v[194:195], v7 offset:4096
    ds_read_b64_tr_b16 v[196:197], v7 offset:4608
    buffer_load_dwordx4 v[230:233], v2, s[40:43], s12 offen offset:0 sc1
    v_mfma_f32_32x32x16_bf16 v[44:59], v[202:205], v[156:159], v[44:59]
    buffer_load_dwordx4 v[234:237], v2, s[40:43], s12 offen offset:1536 sc1
    v_mfma_f32_32x32x16_bf16 v[60:75], v[202:205], v[160:163], v[60:75]
    s_waitcnt vmcnt(6) lgkmcnt(0)
    v_mfma_f32_32x32x16_bf16 v[12:27], v[206:209], v[190:193], v[12:27]
    ds_read_b64_tr_b16 v[182:183], v6 offset:6144
    ds_read_b64_tr_b16 v[184:185], v6 offset:6656
    s_add_u32 s12, s10, 12288
    v_mfma_f32_32x32x16_bf16 v[28:43], v[206:209], v[194:197], v[28:43]
    ds_read_b64_tr_b16 v[186:187], v7 offset:6144
    ds_read_b64_tr_b16 v[188:189], v7 offset:6656
    buffer_load_dwordx4 v[198:201], v2, s[40:43], s12 offen offset:0 sc1
    v_mfma_f32_32x32x16_bf16 v[44:59], v[210:213], v[190:193], v[44:59]
    buffer_load_dwordx4 v[202:205], v2, s[40:43], s12 offen offset:1536 sc1
    v_mfma_f32_32x32x16_bf16 v[60:75], v[210:213], v[194:197], v[60:75]
    s_waitcnt vmcnt(6) lgkmcnt(0)
    v_mfma_f32_32x32x16_bf16 v[12:27], v[214:217], v[182:185], v[12:27]
    ds_read_b64_tr_b16 v[190:191], v6 offset:8192
    ds_read_b64_tr_b16 v[192:193], v6 offset:8704
    s_add_u32 s12, s10, 15360
    v_mfma_f32_32x32x16_bf16 v[28:43], v[214:217], v[186:189], v[28:43]
    ds_read_b64_tr_b16 v[194:195], v7 offset:8192
    ds_read_b64_tr_b16 v[196:197], v7 offset:8704
    buffer_load_dwordx4 v[206:209], v2, s[40:43], s12 offen offset:0 sc1
    v_mfma_f32_32x32x16_bf16 v[44:59], v[218:221], v[182:185], v[44:59]
    v_lshlrev_b32 v152, 16, v164
    v_and_b32 v153, 0xffff0000, v164
    buffer_load_dwordx4 v[210:213], v2, s[40:43], s12 offen offset:1536 sc1
    v_mfma_f32_32x32x16_bf16 v[60:75], v[218:221], v[186:189], v[60:75]
    v_lshlrev_b32 v154, 16, v165
    v_and_b32 v155, 0xffff0000, v165
    s_waitcnt vmcnt(6) lgkmcnt(0)
    v_mfma_f32_32x32x16_bf16 v[12:27], v[222:225], v[190:193], v[12:27]
    ds_read_b64_tr_b16 v[182:183], v8 offset:40960
    ds_read_b64_tr_b16 v[184:185], v8 offset:41472
    s_add_u32 s12, s10, 18432
    v_mfma_f32_32x32x16_bf16 v[28:43], v[222:225], v[194:197], v[28:43]
    ds_read_b64_tr_b16 v[186:187], v9 offset:40960
    ds_read_b64_tr_b16 v[188:189], v9 offset:41472
    buffer_load_dwordx4 v[214:217], v2, s[40:43], s12 offen offset:0 sc1
    v_mfma_f32_32x32x16_bf16 v[44:59], v[226:229], v[190:193], v[44:59]
    v_lshlrev_b32 v156, 16, v166
    v_and_b32 v157, 0xffff0000, v166
    buffer_load_dwordx4 v[218:221], v2, s[40:43], s12 offen offset:1536 sc1
    v_mfma_f32_32x32x16_bf16 v[60:75], v[226:229], v[194:197], v[60:75]
    v_lshlrev_b32 v158, 16, v167
    v_and_b32 v159, 0xffff0000, v167
    s_waitcnt vmcnt(6) lgkmcnt(0)
    v_mfma_f32_32x32x16_bf16 v[12:27], v[230:233], v[182:185], v[12:27]
    ds_read_b64_tr_b16 v[190:191], v8 offset:43008
    ds_read_b64_tr_b16 v[192:193], v8 offset:43520
    s_add_u32 s12, s10, 21504
    v_mfma_f32_32x32x16_bf16 v[28:43], v[230:233], v[186:189], v[28:43]
    ds_read_b64_tr_b16 v[194:195], v9 offset:43008
    ds_read_b64_tr_b16 v[196:197], v9 offset:43520
    buffer_load_dwordx4 v[222:225], v2, s[40:43], s12 offen offset:0 sc1
    v_mfma_f32_32x32x16_bf16 v[44:59], v[234:237], v[182:185], v[44:59]
    v_lshlrev_b32 v164, 16, v168
    v_and_b32 v165, 0xffff0000, v168
    buffer_load_dwordx4 v[226:229], v2, s[40:43], s12 offen offset:1536 sc1
    v_mfma_f32_32x32x16_bf16 v[60:75], v[234:237], v[186:189], v[60:75]
    v_lshlrev_b32 v166, 16, v169
    v_and_b32 v167, 0xffff0000, v169
    s_waitcnt vmcnt(6) lgkmcnt(0)
    v_mfma_f32_32x32x16_bf16 v[12:27], v[198:201], v[190:193], v[12:27]
    ds_read_b64_tr_b16 v[182:183], v8 offset:45056
    ds_read_b64_tr_b16 v[184:185], v8 offset:45568
    buffer_load_dwordx2 v[10:11], v5, s[40:43], s14 offen sc1
    s_add_u32 s12, s10, 24576
    v_mfma_f32_32x32x16_bf16 v[28:43], v[198:201], v[194:197], v[28:43]
    ds_read_b64_tr_b16 v[186:187], v9 offset:45056
    ds_read_b64_tr_b16 v[188:189], v9 offset:45568
    buffer_load_dwordx4 v[230:233], v2, s[40:43], s12 offen offset:0 sc1
    v_mfma_f32_32x32x16_bf16 v[44:59], v[202:205], v[190:193], v[44:59]
    v_lshlrev_b32 v168, 16, v170
    v_and_b32 v169, 0xffff0000, v170
    buffer_load_dwordx4 v[234:237], v2, s[40:43], s12 offen offset:1536 sc1
    v_mfma_f32_32x32x16_bf16 v[60:75], v[202:205], v[194:197], v[60:75]
    v_lshlrev_b32 v170, 16, v171
    v_and_b32 v171, 0xffff0000, v171
    s_waitcnt vmcnt(7) lgkmcnt(0)
    v_mfma_f32_32x32x16_bf16 v[12:27], v[206:209], v[182:185], v[12:27]
    ds_read_b64_tr_b16 v[190:191], v8 offset:47104
    ds_read_b64_tr_b16 v[192:193], v8 offset:47616
    s_add_u32 s12, s10, 27648
    s_cmp_ge_u32 s12, s11
    s_cselect_b32 s12, 1073741824, s12
    v_mfma_f32_32x32x16_bf16 v[28:43], v[206:209], v[186:189], v[28:43]
    ds_read_b64_tr_b16 v[194:195], v9 offset:47104
    ds_read_b64_tr_b16 v[196:197], v9 offset:47616
    buffer_load_dwordx4 v[198:201], v2, s[40:43], s12 offen offset:0 sc1
    v_mfma_f32_32x32x16_bf16 v[44:59], v[210:213], v[182:185], v[44:59]
    v_add_f32 v164, v164, v152
    v_add_f32 v165, v165, v153
    buffer_load_dwordx4 v[202:205], v2, s[40:43], s12 offen offset:1536 sc1
    v_mfma_f32_32x32x16_bf16 v[60:75], v[210:213], v[186:189], v[60:75]
    v_add_f32 v166, v166, v154
    v_add_f32 v167, v167, v155
    s_waitcnt vmcnt(7) lgkmcnt(0)
    v_mfma_f32_32x32x16_bf16 v[12:27], v[214:217], v[190:193], v[12:27]
    ds_read_b64_tr_b16 v[182:183], v8 offset:0
    ds_read_b64_tr_b16 v[184:185], v8 offset:512
    s_add_u32 s12, s10, 30720
    s_cmp_ge_u32 s12, s11
    s_cselect_b32 s12, 1073741824, s12
    v_mfma_f32_32x32x16_bf16 v[28:43], v[214:217], v[194:197], v[28:43]
    ds_read_b64_tr_b16 v[186:187], v9 offset:0
    ds_read_b64_tr_b16 v[188:189], v9 offset:512
    buffer_load_dwordx4 v[206:209], v2, s[40:43], s12 offen offset:0 sc1
    v_mfma_f32_32x32x16_bf16 v[44:59], v[218:221], v[190:193], v[44:59]
    v_add_f32 v168, v168, v156
    v_add_f32 v169, v169, v157
    buffer_load_dwordx4 v[210:213], v2, s[40:43], s12 offen offset:1536 sc1
    v_mfma_f32_32x32x16_bf16 v[60:75], v[218:221], v[194:197], v[60:75]
    v_add_f32 v170, v170, v158
    v_add_f32 v171, v171, v159
    s_waitcnt vmcnt(7) lgkmcnt(0)
    v_mfma_f32_32x32x16_bf16 v[12:27], v[222:225], v[182:185], v[12:27]
    ds_read_b64_tr_b16 v[190:191], v8 offset:2048
    ds_read_b64_tr_b16 v[192:193], v8 offset:2560
    s_waitcnt vmcnt(6)
    v_cmp_eq_u64 vcc, s[26:27], v[10:11]
    s_nop 0
    s_cmp_eq_u64 vcc, exec
    s_cbranch_scc0 L_pollslow_19
L_polldone_20:
    s_lshl1_add_u32 s56, s45, s15
    s_xor_b32 s57, s56, 1
    s_mul_i32 s7, s56, 12288
    s_mul_i32 s10, s57, 12288
    s_add_u32 s7, s7, s11
    s_add_u32 s10, s10, s11
    s_add_u32 s12, s7, 0
    v_mfma_f32_32x32x16_bf16 v[28:43], v[222:225], v[186:189], v[28:43]
    ds_read_b64_tr_b16 v[194:195], v9 offset:2048
    ds_read_b64_tr_b16 v[196:197], v9 offset:2560
    buffer_load_dwordx4 v[214:217], v2, s[40:43], s12 offen offset:0 sc1
    v_mfma_f32_32x32x16_bf16 v[44:59], v[226:229], v[182:185], v[44:59]
    v_lshlrev_b32 v172, 16, v176
    v_and_b32 v173, 0xffff0000, v176
    buffer_load_dwordx4 v[218:221], v2, s[40:43], s12 offen offset:3072 sc1
    v_mfma_f32_32x32x16_bf16 v[60:75], v[226:229], v[186:189], v[60:75]
    v_lshlrev_b32 v174, 16, v177
    v_and_b32 v175, 0xffff0000, v177
    s_waitcnt vmcnt(6) lgkmcnt(0)
    v_mfma_f32_32x32x16_bf16 v[12:27], v[230:233], v[190:193], v[12:27]
    ds_read_b64_tr_b16 v[182:183], v8 offset:4096
    ds_read_b64_tr_b16 v[184:185], v8 offset:4608
    s_add_u32 s12, s7, 6144
    v_mfma_f32_32x32x16_bf16 v[28:43], v[230:233], v[194:197], v[28:43]
    ds_read_b64_tr_b16 v[186:187], v9 offset:4096
    ds_read_b64_tr_b16 v[188:189], v9 offset:4608
    buffer_load_dwordx4 v[222:225], v2, s[40:43], s12 offen offset:0 sc1
    v_mfma_f32_32x32x16_bf16 v[44:59], v[234:237], v[190:193], v[44:59]
    v_lshlrev_b32 v176, 16, v178
    v_and_b32 v177, 0xffff0000, v178
    buffer_load_dwordx4 v[226:229], v2, s[40:43], s12 offen offset:3072 sc1
    v_mfma_f32_32x32x16_bf16 v[60:75], v[234:237], v[194:197], v[60:75]
    v_lshlrev_b32 v178, 16, v179
    v_and_b32 v179, 0xffff0000, v179
    s_waitcnt vmcnt(6) lgkmcnt(0)
    v_mfma_f32_32x32x16_bf16 v[12:27], v[198:201], v[182:185], v[12:27]
    ds_read_b64_tr_b16 v[190:191], v8 offset:6144
    ds_read_b64_tr_b16 v[192:193], v8 offset:6656
    s_add_u32 s12, s10, 0
    v_mfma_f32_32x32x16_bf16 v[28:43], v[198:201], v[186:189], v[28:43]
    ds_read_b64_tr_b16 v[194:195], v9 offset:6144
    ds_read_b64_tr_b16 v[196:197], v9 offset:6656
    buffer_load_dwordx4 v[230:233], v2, s[40:43], s12 offen offset:0 sc1
    v_mfma_f32_32x32x16_bf16 v[44:59], v[202:205], v[182:185], v[44:59]
    v_add_f32 v172, v172, v152
    v_add_f32 v173, v173, v153
    buffer_load_dwordx4 v[234:237], v2, s[40:43], s12 offen offset:3072 sc1
    v_mfma_f32_32x32x16_bf16 v[60:75], v[202:205], v[186:189], v[60:75]
    v_add_f32 v174, v174, v154
    v_add_f32 v175, v175, v155
    s_waitcnt vmcnt(6) lgkmcnt(0)
    v_mfma_f32_32x32x16_bf16 v[12:27], v[206:209], v[190:193], v[12:27]
    s_add_u32 s12, s10, 6144
    v_mfma_f32_32x32x16_bf16 v[28:43], v[206:209], v[194:197], v[28:43]
    buffer_load_dwordx4 v[198:201], v2, s[40:43], s12 offen offset:0 sc1
    v_mfma_f32_32x32x16_bf16 v[44:59], v[210:213], v[190:193], v[44:59]
    v_add_f32 v176, v176, v156
    v_add_f32 v177, v177, v157
    buffer_load_dwordx4 v[202:205], v2, s[40:43], s12 offen offset:3072 sc1
    v_mfma_f32_32x32x16_bf16 v[60:75], v[210:213], v[194:197], v[60:75]
    v_add_f32 v178, v178, v158
    v_add_f32 v179, v179, v159
    s_waitcnt vmcnt(6) lgkmcnt(0)
    v_mfma_f32_32x32x16_bf16 v[12:27], v[214:217], v[76:79], v[12:27]
    s_add_u32 s12, s7, 1536
    v_mfma_f32_32x32x16_bf16 v[28:43], v[214:217], v[80:83], v[28:43]
    buffer_load_dwordx4 v[206:209], v2, s[40:43], s12 offen offset:0 sc1
    v_mfma_f32_32x32x16_bf16 v[12:27], v[218:221], v[84:87], v[12:27]
    buffer_load_dwordx4 v[210:213], v2, s[40:43], s12 offen offset:3072 sc1
    v_mfma_f32_32x32x16_bf16 v[28:43], v[218:221], v[88:91], v[28:43]
    s_waitcnt vmcnt(6)
    v_mfma_f32_32x32x16_bf16 v[12:27], v[222:225], v[92:95], v[12:27]
    s_add_u32 s12, s7, 7680
    v_mfma_f32_32x32x16_bf16 v[28:43], v[222:225], v[96:99], v[28:43]
    buffer_load_dwordx4 v[214:217], v2, s[40:43], s12 offen offset:0 sc1
    v_mfma_f32_32x32x16_bf16 v[12:27], v[226:229], v[100:103], v[12:27]
    buffer_load_dwordx4 v[218:221], v2, s[40:43], s12 offen offset:3072 sc1
    v_mfma_f32_32x32x16_bf16 v[28:43], v[226:229], v[104:107], v[28:43]
    s_waitcnt vmcnt(6)
    v_mfma_f32_32x32x16_bf16 v[12:27], v[230:233], v[108:111], v[12:27]
    s_add_u32 s12, s10, 1536
    v_mfma_f32_32x32x16_bf16 v[28:43], v[230:233], v[112:115], v[28:43]
    buffer_load_dwordx4 v[222:225], v2, s[40:43], s12 offen offset:0 sc1
    v_mfma_f32_32x32x16_bf16 v[12:27], v[234:237], v[116:119], v[12:27]
    buffer_load_dwordx4 v[226:229], v2, s[40:43], s12 offen offset:3072 sc1
    v_mfma_f32_32x32x16_bf16 v[28:43], v[234:237], v[120:123], v[28:43]
    s_waitcnt vmcnt(6)
    v_mfma_f32_32x32x16_bf16 v[12:27], v[198:201], v[124:127], v[12:27]
    s_add_u32 s12, s10, 7680
    v_mfma_f32_32x32x16_bf16 v[28:43], v[198:201], v[128:131], v[28:43]
    buffer_load_dwordx4 v[230:233], v2, s[40:43], s12 offen offset:0 sc1
    v_mfma_f32_32x32x16_bf16 v[12:27], v[202:205], v[132:135], v[12:27]
    buffer_load_dwordx4 v[234:237], v2, s[40:43], s12 offen offset:3072 sc1
    v_mfma_f32_32x32x16_bf16 v[28:43], v[202:205], v[136:139], v[28:43]
    s_waitcnt vmcnt(6)
    v_mfma_f32_32x32x16_bf16 v[44:59], v[206:209], v[76:79], v[44:59]
    v_mfma_f32_32x32x16_bf16 v[60:75], v[206:209], v[80:83], v[60:75]
    v_mfma_f32_32x32x16_bf16 v[44:59], v[210:213], v[84:87], v[44:59]
    s_nop 5
    ds_write_addtid_b32 v12 offset:0
    ds_write_addtid_b32 v13 offset:272
    ds_write_addtid_b32 v14 offset:640
    ds_write_addtid_b32 v15 offset:912
    v_mfma_f32_32x32x16_bf16 v[60:75], v[210:213], v[88:91], v[60:75]
    ds_write_addtid_b32 v16 offset:1280
    ds_write_addtid_b32 v17 offset:1552
    ds_write_addtid_b32 v18 offset:1920
    ds_write_addtid_b32 v19 offset:2192
    s_waitcnt vmcnt(4)
    v_mfma_f32_32x32x16_bf16 v[44:59], v[214:217], v[92:95], v[44:59]
    ds_write_addtid_b32 v20 offset:2560
    ds_write_addtid_b32 v21 offset:2832
    ds_write_addtid_b32 v22 offset:3200
    ds_write_addtid_b32 v23 offset:3472
    v_mfma_f32_32x32x16_bf16 v[60:75], v[214:217], v[96:99], v[60:75]
    ds_write_addtid_b32 v24 offset:3840
    ds_write_addtid_b32 v25 offset:4112
    ds_write_addtid_b32 v26 offset:4480
    ds_write_addtid_b32 v27 offset:4752
    v_mfma_f32_32x32x16_bf16 v[44:59], v[218:221], v[100:103], v[44:59]
    ds_write_addtid_b32 v28 offset:5120
    ds_write_addtid_b32 v29 offset:5392
    ds_write_addtid_b32 v30 offset:5760
    ds_write_addtid_b32 v31 offset:6032
    v_mfma_f32_32x32x16_bf16 v[60:75], v[218:221], v[104:107], v[60:75]
    ds_write_addtid_b32 v32 offset:6400
    ds_write_addtid_b32 v33 offset:6672
    ds_write_addtid_b32 v34 offset:7040
    ds_write_addtid_b32 v35 offset:7312
    s_waitcnt vmcnt(2)
    v_mfma_f32_32x32x16_bf16 v[44:59], v[222:225], v[108:111], v[44:59]
    ds_write_addtid_b32 v36 offset:7680
    ds_write_addtid_b32 v37 offset:7952
    ds_write_addtid_b32 v38 offset:8320
    ds_write_addtid_b32 v39 offset:8592
    v_mfma_f32_32x32x16_bf16 v[60:75], v[222:225], v[112:115], v[60:75]
    ds_write_addtid_b32 v40 offset:8960
    ds_write_addtid_b32 v41 offset:9232
    ds_write_addtid_b32 v42 offset:9600
    ds_write_addtid_b32 v43 offset:9872
    v_mfma_f32_32x32x16_bf16 v[44:59], v[226:229], v[116:119], v[44:59]
    v_mfma_f32_32x32x16_bf16 v[60:75], v[226:229], v[120:123], v[60:75]
    s_waitcnt lgkmcnt(0)
    s_barrier
    s_waitcnt vmcnt(0)
    v_mfma_f32_32x32x16_bf16 v[44:59], v[230:233], v[124:127], v[44:59]
    ds_read_b128 v[140:143], v180 offset:0
    ds_read_b128 v[144:147], v181 offset:0
    ds_read_b128 v[148:151], v180 offset:10240
    ds_read_b128 v[152:155], v181 offset:10240
    v_mfma_f32_32x32x16_bf16 v[60:75], v[230:233], v[128:131], v[60:75]
    ds_read_b128 v[156:159], v180 offset:20480
    ds_read_b128 v[160:163], v181 offset:20480
    ds_read_b128 v[182:185], v180 offset:30720
    ds_read_b128 v[186:189], v181 offset:30720
    v_add_u32 v180, 40960, v180
    v_add_u32 v181, 40960, v181
    v_mfma_f32_32x32x16_bf16 v[44:59], v[234:237], v[132:135], v[44:59]
    v_mfma_f32_32x32x16_bf16 v[60:75], v[234:237], v[136:139], v[60:75]
    s_waitcnt lgkmcnt(0)
    v_pk_add_f32 v[164:165], v[164:165], v[140:141]
    v_pk_add_f32 v[166:167], v[166:167], v[142:143]
    v_pk_add_f32 v[168:169], v[168:169], v[144:145]
    v_pk_add_f32 v[170:171], v[170:171], v[146:147]
    v_pk_add_f32 v[164:165], v[164:165], v[148:149]
    v_pk_add_f32 v[166:167], v[166:167], v[150:151]
    v_pk_add_f32 v[168:169], v[168:169], v[152:153]
    v_pk_add_f32 v[170:171], v[170:171], v[154:155]
    v_pk_add_f32 v[164:165], v[164:165], v[156:157]
    s_nop 0
    ds_write_addtid_b32 v44 offset:40960
    ds_write_addtid_b32 v45 offset:41232
    ds_write_addtid_b32 v46 offset:41600
    ds_write_addtid_b32 v47 offset:41872
    v_pk_add_f32 v[166:167], v[166:167], v[158:159]
    v_pk_add_f32 v[168:169], v[168:169], v[160:161]
    ds_write_addtid_b32 v48 offset:42240
    ds_write_addtid_b32 v49 offset:42512
    ds_write_addtid_b32 v50 offset:42880
    ds_write_addtid_b32 v51 offset:43152
    v_pk_add_f32 v[170:171], v[170:171], v[162:163]
    v_pk_add_f32 v[164:165], v[164:165], v[182:183]
    ds_write_addtid_b32 v52 offset:43520
    ds_write_addtid_b32 v53 offset:43792
    ds_write_addtid_b32 v54 offset:44160
    ds_write_addtid_b32 v55 offset:44432
    v_pk_add_f32 v[166:167], v[166:167], v[184:185]
    v_pk_add_f32 v[168:169], v[168:169], v[186:187]
    ds_write_addtid_b32 v56 offset:44800
    ds_write_addtid_b32 v57 offset:45072
    ds_write_addtid_b32 v58 offset:45440
    ds_write_addtid_b32 v59 offset:45712
    v_pk_add_f32 v[170:171], v[170:171], v[188:189]
    v_cvt_pk_bf16_f32 v190, v164, v165
    ds_write_addtid_b32 v60 offset:46080
    ds_write_addtid_b32 v61 offset:46352
    ds_write_addtid_b32 v62 offset:46720
    ds_write_addtid_b32 v63 offset:46992
    v_cvt_pk_bf16_f32 v191, v166, v167
    v_cvt_pk_bf16_f32 v192, v168, v169
    ds_write_addtid_b32 v64 offset:47360
    ds_write_addtid_b32 v65 offset:47632
    ds_write_addtid_b32 v66 offset:48000
    ds_write_addtid_b32 v67 offset:48272
    v_cvt_pk_bf16_f32 v193, v170, v171
    buffer_store_dwordx4 v[190:193], v4, s[32:35], s13 offen sc1
    ds_write_addtid_b32 v68 offset:48640
    ds_write_addtid_b32 v69 offset:48912
    ds_write_addtid_b32 v70 offset:49280
    ds_write_addtid_b32 v71 offset:49552
    ds_write_addtid_b32 v72 offset:49920
    ds_write_addtid_b32 v73 offset:50192
    ds_write_addtid_b32 v74 offset:50560
    ds_write_addtid_b32 v75 offset:50832
    s_waitcnt lgkmcnt(0)
    s_barrier
    ds_read_b128 v[12:15], v180 offset:0
    ds_read_b128 v[16:19], v181 offset:0
    ds_read_b128 v[20:23], v180 offset:10240
    ds_read_b128 v[24:27], v181 offset:10240
    ds_read_b128 v[28:31], v180 offset:20480
    ds_read_b128 v[32:35], v181 offset:20480
    ds_read_b128 v[36:39], v180 offset:30720
    ds_read_b128 v[40:43], v181 offset:30720
    s_waitcnt lgkmcnt(6)
    v_pk_add_f32 v[172:173], v[172:173], v[12:13]
    v_pk_add_f32 v[174:175], v[174:175], v[14:15]
    v_pk_add_f32 v[176:177], v[176:177], v[16:17]
    v_pk_add_f32 v[178:179], v[178:179], v[18:19]
    s_waitcnt lgkmcnt(4)
    v_pk_add_f32 v[172:173], v[172:173], v[20:21]
    v_pk_add_f32 v[174:175], v[174:175], v[22:23]
    v_pk_add_f32 v[176:177], v[176:177], v[24:25]
    v_pk_add_f32 v[178:179], v[178:179], v[26:27]
    s_waitcnt lgkmcnt(2)
    v_pk_add_f32 v[172:173], v[172:173], v[28:29]
    v_pk_add_f32 v[174:175], v[174:175], v[30:31]
    v_pk_add_f32 v[176:177], v[176:177], v[32:33]
    v_pk_add_f32 v[178:179], v[178:179], v[34:35]
    s_waitcnt lgkmcnt(0)
    v_pk_add_f32 v[172:173], v[172:173], v[36:37]
    v_pk_add_f32 v[174:175], v[174:175], v[38:39]
    v_pk_add_f32 v[176:177], v[176:177], v[40:41]
    v_pk_add_f32 v[178:179], v[178:179], v[42:43]
    v_cvt_pk_bf16_f32 v194, v172, v173
    v_cvt_pk_bf16_f32 v195, v174, v175
    v_cvt_pk_bf16_f32 v196, v176, v177
    v_cvt_pk_bf16_f32 v197, v178, v179
    buffer_store_dwordx4 v[194:197], v4, s[32:35], s59 offen sc1
    s_or_b32 s54, s2, s45
    s_cmp_lg_u32 s54, 0
    s_cbranch_scc1 L_Bfin
    v_mov_b32 v10, s26
    v_mov_b32 v11, s27
    v_mov_b32 v230, 15368192
    buffer_store_dwordx2 v[10:11], v230, s[40:43], 0 offen sc1
L_Bfin:
    s_endpgm
L_pollslow_10:
    s_mov_b32 s3, 0
L_poll_9:
    s_sleep 1
    buffer_load_dwordx4 v[60:63], v217, s[40:43], s57 offen sc1
    s_xor_b32 s12, s56, 4096
    buffer_load_dwordx4 v[12:15], v218, s[40:43], s12 offen sc1
    s_xor_b32 s12, s56, 8192
    buffer_load_dwordx4 v[16:19], v218, s[40:43], s12 offen sc1
    s_xor_b32 s12, s56, 12288
    buffer_load_dwordx4 v[20:23], v218, s[40:43], s12 offen sc1
    s_add_u32 s3, s3, 1
    s_waitcnt vmcnt(0)
    v_xor_b32 v232, v15, v19
    v_xor_b32 v233, v23, v71
    v_xor_b32 v234, v15, v71
    v_or3_b32 v232, v232, v233, v234
    v_xor_b32 v63, v63, v232
    v_cmp_eq_u64 vcc, s[26:27], v[62:63]
    s_cmp_lt_u32 s3, 262144
    s_cselect_b64 vcc, vcc, exec
    s_cmp_eq_u64 vcc, exec
    s_cbranch_scc0 L_poll_9
    s_branch L_polldone_11
L_pollslow_16:
    s_mov_b32 s3, 0
L_poll_15:
    s_sleep 4
    buffer_load_dwordx2 v[10:11], v5, s[40:43], s60 offen sc1
    s_add_u32 s3, s3, 1
    s_waitcnt vmcnt(0)
    v_cmp_eq_u64 vcc, s[26:27], v[10:11]
    s_cmp_lt_u32 s3, 262144
    s_cselect_b64 vcc, vcc, exec
    s_cmp_eq_u64 vcc, exec
    s_cbranch_scc0 L_poll_15
    s_branch L_polldone_17
L_pollslow_19:
    s_mov_b32 s3, 0
L_poll_18:
    s_sleep 1
    buffer_load_dwordx2 v[10:11], v5, s[40:43], s14 offen sc1
    s_add_u32 s3, s3, 1
    s_waitcnt vmcnt(0)
    v_cmp_eq_u64 vcc, s[26:27], v[10:11]
    s_cmp_lt_u32 s3, 262144
    s_cselect_b64 vcc, vcc, exec
    s_cmp_eq_u64 vcc, exec
    s_cbranch_scc0 L_poll_18
    s_branch L_polldone_20
L_nordyH:
    ds_read_b128 v[232:235], v0
    ds_read_b128 v[104:107], v7 offset:0
    ds_read_b128 v[108:111], v7 offset:256
    ds_read_b128 v[112:115], v7 offset:512
    ds_read_b64 v[132:133], v6 offset:0
    ds_read_b64 v[134:135], v6 offset:128
    ds_read_b64 v[136:137], v6 offset:256
    ds_read_b64 v[138:139], v6 offset:384
    ds_read_b64 v[140:141], v6 offset:512
    ds_read_b64 v[142:143], v6 offset:640
    ds_read_b64 v[144:145], v6 offset:768
    ds_read_b64 v[146:147], v6 offset:896
    s_waitcnt lgkmcnt(0)
    v_min3_u32 v232, v232, v233, v234
    v_min_u32 v232, v232, v235
    v_cmp_ne_u32 vcc, 0, v232
    s_nop 0
    s_cmp_eq_u64 vcc, exec
    s_cbranch_scc0 L_nordyH
    s_branch L_rdyH
L_nordyQ:
    ds_read_b128 v[104:107], v0
    ds_read_b32 v112, v4 offset:512
    ds_read_b32 v108, v4 offset:256
    ds_read_b128 v[132:135], v5 offset:0
    ds_read_b128 v[220:223], v5 offset:512
    ds_read_b128 v[136:139], v5 offset:64
    ds_read_b128 v[224:227], v5 offset:576
    ds_read_b128 v[140:143], v5 offset:128
    ds_read_b128 v[228:231], v5 offset:640
    ds_read_b128 v[144:147], v5 offset:192
    ds_read_b128 v[232:235], v5 offset:704
    ds_read_b128 v[148:151], v5 offset:256
    ds_read_b128 v[236:239], v5 offset:768
    ds_read_b128 v[152:155], v5 offset:320
    ds_read_b128 v[240:243], v5 offset:832
    ds_read_b128 v[156:159], v5 offset:384
    ds_read_b128 v[244:247], v5 offset:896
    ds_read_b128 v[160:163], v5 offset:448
    ds_read_b128 v[248:251], v5 offset:960
    s_waitcnt lgkmcnt(0)
    v_min3_u32 v104, v104, v105, v106
    v_min_u32 v104, v104, v107
    v_cmp_ne_u32 vcc, 0, v104
    s_nop 0
    s_cmp_eq_u64 vcc, exec
    s_cbranch_scc0 L_nordyQ
    s_branch L_rdyQ
L_end:
    s_endpgm
.section .rodata,"a"
.p2align 6
.amdhsa_kernel parallel_sum__linear_attn_block__dense_activation_squared_relu__prompt_kernel
  .amdhsa_next_free_vgpr 256
  .amdhsa_next_free_sgpr 102
  .amdhsa_accum_offset 256
  .amdhsa_group_segment_fixed_size 0
  .amdhsa_kernarg_size 88
  .amdhsa_user_sgpr_count 2
  .amdhsa_user_sgpr_kernarg_segment_ptr 1
  .amdhsa_system_sgpr_workgroup_id_x 1
  .amdhsa_float_denorm_mode_32 3
.end_amdhsa_kernel
```
